```python
import torch

def _softmax(x, axis=-1):
    return torch.softmax(x, dim=axis)
def _gelu(x):
    return torch.nn.functional.gelu(x, approximate="tanh")
def _silu(x):
    return torch.nn.functional.silu(x)
def _sigmoid(x):
    return torch.sigmoid(x)
def _layernorm(x, axis=-1, eps=1e-5):
    m = x.mean(dim=axis, keepdim=True)
    v = x.var(dim=axis, keepdim=True, unbiased=False)
    return (x - m) / torch.sqrt(v + eps)
def _scatter_add(tgt, idx, src, axis=0):
    return tgt.clone().index_add_(axis, idx, src)
def _segment_sum(src, seg, n):
    out = torch.zeros((n,) + src.shape[1:], dtype=src.dtype)
    return out.index_add_(0, seg, src)
def _pad(x, pw):
    flat = tuple(v for pair in reversed(pw) for v in pair)
    return torch.nn.functional.pad(x, flat)

kernel_name = 'concat_heads__sliding_local_dilated__softmax_full_mha__prompt'

def setup_inputs():

    _w = (lambda a: (lambda t: t.to(torch.bfloat16) if t.is_floating_point() else t)(torch.as_tensor(a)))
    def _A_setup():
        B, S, D = 1, 2048, 448
        return {
            "x": _w((lambda *s: torch.randn(*s, dtype=torch.bfloat16) * 0.4)(B, S, D)),
            "wqkv": _w((lambda *s: torch.randn(*s, dtype=torch.bfloat16) * 0.8)(D, 3 * D)),
            "wo": _w((lambda *s: torch.randn(*s, dtype=torch.bfloat16) * 0.1)(D, D)),
        }
    _A_in = _A_setup()

    def _B_setup():
        B, S, D = 1, 2048, 448
        return {
            "x": _w((lambda *s: torch.randn(*s, dtype=torch.bfloat16) * 0.2)(B, S, D)),
            "wqkv": _w((lambda *s: torch.randn(*s, dtype=torch.bfloat16) * 0.8)(D, 3 * D)),
            "wo": _w((lambda *s: torch.randn(*s, dtype=torch.bfloat16) * 0.2)(D, D)),
        }
    _B_in = _B_setup()

    return {
        "A_x": _A_in["x"],
        "A_wqkv": _A_in["wqkv"],
        "A_wo": _A_in["wo"],
        "B_x": _B_in["x"],
        "B_wqkv": _B_in["wqkv"],
        "B_wo": _B_in["wo"],
    }

def reference(A_x, A_wqkv, A_wo, B_x, B_wqkv, B_wo):
    def _A_ref(x, wqkv, wo):
        B, S, D = x.shape
        H = 16; Dh = D // H
        W, dil = 8, 2
        qkv = (lambda x, *d: x.permute(*d))((x @ wqkv).reshape(B, S, 3, H, Dh), 2, 0, 3, 1, 4)
        q, k, v = qkv[0], qkv[1], qkv[2]
        scale = Dh ** -0.5
        pos = torch.arange(S)
        off = torch.arange(W) * dil
        idx = pos[:, None] - off[None, :]
        mask = idx >= 0
        idx_c = torch.where(mask, idx, 0).reshape(-1)
        kg = k[:, :, idx_c, :].reshape(B, H, S, W, Dh)
        vg = v[:, :, idx_c, :].reshape(B, H, S, W, Dh)
        logits = torch.einsum("bhsd,bhswd->bhsw", q, kg) * scale
        logits = torch.where(mask[None, None, :, :], logits, -1e9)
        attn = _softmax(logits, axis=-1)
        o = torch.einsum("bhsw,bhswd->bhsd", attn, vg)
        return (lambda x, *d: x.permute(*d))(o, 0, 2, 1, 3).reshape(B, S, D) @ wo

    def _B_ref(x, wqkv, wo):
        B, S, D = x.shape
        H = 16; Dh = D // H
        qkv = (lambda x, *d: x.permute(*d))((x @ wqkv).reshape(B, S, 3, H, Dh), 2, 0, 3, 1, 4)
        q, k, v = qkv[0], qkv[1], qkv[2]
        scale = Dh ** -0.5
        scores = torch.einsum("bhqd,bhkd->bhqk", q, k) * scale
        p = _softmax(scores, axis=-1)
        o = torch.einsum("bhqk,bhkd->bhqd", p, v)
        return (lambda x, *d: x.permute(*d))(o, 0, 2, 1, 3).reshape(B, S, D) @ wo

    a = _A_ref(A_x, A_wqkv, A_wo)
    b = _B_ref(B_x, B_wqkv, B_wo)
    return torch.concatenate([a, b], axis=-1)
```

```asm
; @launch grid=(256,1,1) block=(768,1,1) lds=163840
.amdgcn_target "amdgcn-amd-amdhsa--gfx950"
.text
.globl concat_heads__sliding_local_dilated__softmax_full_mha__prompt_kernel
.p2align 8
.type concat_heads__sliding_local_dilated__softmax_full_mha__prompt_kernel,@function
concat_heads__sliding_local_dilated__softmax_full_mha__prompt_kernel:
    s_cmp_ge_u32 s2, 256
    s_cbranch_scc1 L_END
    s_load_dwordx16 s[4:19], s[0:1], 0
    s_load_dwordx2 s[20:21], s[0:1], 64
    v_lshrrev_b32 v1, 6, v0
    v_and_b32 v0, 63, v0
    v_readfirstlane_b32 s40, v1
    v_lshlrev_b32 v1, 4, v0
    s_and_b32 s41, s2, 3
    s_lshl_b32 s41, s41, 2
    s_bfe_u32 s3, s2, 0x20003
    s_add_u32 s41, s41, s3
    s_bfe_u32 s42, s2, 0x10002
    s_lshl_b32 s42, s42, 3
    s_lshr_b32 s3, s2, 5
    s_add_u32 s42, s42, s3
    s_cmp_lt_u32 s40, 8
    s_cbranch_scc1 L_COMPUTE
    s_setprio 3
    s_sub_u32 s48, s40, 8
    v_lshrrev_b32 v2, 3, v0
    v_and_b32 v3, 7, v0
    v_lshrrev_b32 v12, 4, v0
    v_add_u32 v13, 0, v12
    v_and_b32 v13, 7, v13
    v_xor_b32 v13, v13, v3
    v_add_u32 v14, 0, v2
    v_mul_u32_u24 v8, 896, v14
    v_lshl_add_u32 v4, v13, 4, v8
    v_add_u32 v13, 4, v12
    v_and_b32 v13, 7, v13
    v_xor_b32 v13, v13, v3
    v_add_u32 v14, 8, v2
    v_mul_u32_u24 v9, 896, v14
    v_lshl_add_u32 v5, v13, 4, v9
    v_add_u32 v13, 8, v12
    v_and_b32 v13, 7, v13
    v_xor_b32 v13, v13, v3
    v_add_u32 v14, 16, v2
    v_mul_u32_u24 v10, 896, v14
    v_lshl_add_u32 v6, v13, 4, v10
    v_add_u32 v13, 12, v12
    v_and_b32 v13, 7, v13
    v_xor_b32 v13, v13, v3
    v_add_u32 v14, 24, v2
    v_mul_u32_u24 v11, 896, v14
    v_lshl_add_u32 v7, v13, 4, v11
    s_mov_b32 s3, 5462
    v_add_u32 v15, 0, v0
    v_mul_lo_u32 v16, v15, s3
    v_lshrrev_b32 v16, 16, v16
    v_mul_u32_u24 v17, 12, v16
    v_sub_u32 v15, v15, v17
    v_min_u32 v15, 10, v15
    v_mul_u32_u24 v16, 2688, v16
    v_lshl_add_u32 v12, v15, 4, v16
    v_add_u32 v15, 64, v0
    v_mul_lo_u32 v16, v15, s3
    v_lshrrev_b32 v16, 16, v16
    v_mul_u32_u24 v17, 12, v16
    v_sub_u32 v15, v15, v17
    v_min_u32 v15, 10, v15
    v_mul_u32_u24 v16, 2688, v16
    v_lshl_add_u32 v13, v15, 4, v16
    v_add_u32 v15, 128, v0
    v_mul_lo_u32 v16, v15, s3
    v_lshrrev_b32 v16, 16, v16
    v_mul_u32_u24 v17, 12, v16
    v_sub_u32 v15, v15, v17
    v_min_u32 v15, 10, v15
    v_mul_u32_u24 v16, 2688, v16
    v_lshl_add_u32 v14, v15, 4, v16
    s_lshl_b32 s50, s41, 2
    s_add_u32 s50, s50, s48
    s_mul_i32 s50, s50, 28672
    s_mul_i32 s51, s42, 168
    s_andn2_b32 s51, s51, 15
    s_mul_i32 s3, s48, 43008
    s_add_u32 s51, s51, s3
    s_lshl_b32 s52, s48, 12
    s_mul_i32 s53, s48, 3072
    s_add_u32 s53, s53, 16384
    s_lshl_b32 s49, s42, 1
    s_add_u32 s49, s49, s41
    s_mul_i32 s3, s49, 37
    s_lshr_b32 s3, s3, 8
    s_mul_i32 s3, s3, 7
    s_sub_u32 s49, s49, s3
    s_mov_b32 s54, 57344
    s_mov_b32 s55, 0
    s_waitcnt lgkmcnt(0)
    s_mov_b32 s28, s10
    s_and_b32 s29, s11, 0xffff
    s_mov_b32 s30, 0x1c0000
    s_mov_b32 s31, 0x20000
    s_mov_b32 s32, s12
    s_and_b32 s33, s13, 0xffff
    s_mov_b32 s34, 0x126000
    s_mov_b32 s35, 0x20000
    s_lshl_b32 s56, s49, 7
    s_add_u32 s56, s56, s50
    s_mul_i32 s57, s49, 172032
    s_add_u32 s57, s57, s51
    s_add_u32 s58, s54, s52
    s_add_u32 s59, s54, s53
    s_add_u32 m0, s58, 0
    s_nop 0
    buffer_load_dwordx4 v4, s[28:31], s56 offen lds
    s_add_u32 m0, s58, 1024
    s_nop 0
    buffer_load_dwordx4 v5, s[28:31], s56 offen lds
    s_add_u32 m0, s58, 2048
    s_nop 0
    buffer_load_dwordx4 v6, s[28:31], s56 offen lds
    s_add_u32 m0, s58, 3072
    s_nop 0
    buffer_load_dwordx4 v7, s[28:31], s56 offen lds
    s_add_u32 m0, s59, 0
    s_nop 0
    buffer_load_dwordx4 v12, s[32:35], s57 offen lds
    s_add_u32 m0, s59, 1024
    s_nop 0
    buffer_load_dwordx4 v13, s[32:35], s57 offen lds
    s_add_u32 m0, s59, 2048
    s_nop 0
    buffer_load_dwordx4 v14, s[32:35], s57 offen lds
    s_add_u32 s49, s49, 1
    s_cmp_eq_u32 s49, 7
    s_cselect_b32 s49, 0, s49
    s_add_u32 s54, s54, 28672
    s_cmp_eq_u32 s54, 143360
    s_cselect_b32 s54, 0, s54
    s_and_b32 s43, s2, 15
    s_lshr_b32 s44, s2, 4
    s_and_b32 s45, s2, 7
    s_lshl_b32 s45, s45, 2
    s_bfe_u32 s3, s2, 0x20003
    s_add_u32 s45, s45, s3
    s_lshr_b32 s46, s2, 5
    v_mov_b32 v164, 0x27f00
    v_mov_b32 v166, 0
    s_add_u32 s22, s20, 0x1000000
    s_addc_u32 s23, s21, 0
    s_load_dword s47, s[22:23], 0
    s_mov_b32 s24, s20
    s_and_b32 s25, s21, 0xffff
    s_mov_b32 s26, 0x1020000
    s_mov_b32 s27, 0x20000
    s_lshl_b32 s3, s48, 2
    s_add_u32 s3, s3, 0x27f00
    v_mov_b32 v163, s3
    v_lshrrev_b32 v18, 4, v0
    v_lshlrev_b32 v18, 4, v18
    v_add_u32 v18, s43, v18
    v_mul_u32_u24 v18, 171, v18
    v_lshrrev_b32 v18, 9, v18
    v_min_u32 v18, 15, v18
    v_lshlrev_b32 v18, 7, v18
    v_and_b32 v19, 15, v0
    v_lshl_add_u32 v18, v19, 2, v18
    v_add_u32 v18, 0x1001000, v18
    s_lshl_b32 s61, s42, 7
    s_lshl_b32 s3, s41, 2
    s_add_u32 s61, s61, s3
    s_add_u32 s61, s61, 0x1001000
    s_mov_b32 s55, 1
H_GL:
    s_cmp_lt_u32 s55, 2
    s_cbranch_scc1 H_NOBAR
    s_cmp_eq_u32 s55, 3
    s_cbranch_scc1 H_NOBAR
    s_cmp_eq_u32 s55, 2
    s_cbranch_scc1 H_W7
    s_waitcnt vmcnt(14)
    s_branch H_W
H_W7:
    s_waitcnt vmcnt(7)
H_W:
    s_barrier
    s_cmp_lg_u32 s55, 12
    s_cbranch_scc1 H_NOBAR
    s_cmp_lg_u32 s48, 0
    s_cbranch_scc1 H_NOBAR
    s_mov_b64 exec, 1
    buffer_store_dword v165, v166, s[24:27], s61 offen sc1
    s_mov_b64 exec, -1
H_NOBAR:
    s_cmp_lg_u32 s55, 7
    s_cbranch_scc1 H_NOSW
    s_mov_b32 s28, s4
    s_and_b32 s29, s5, 0xffff
    s_mov_b32 s30, 0x1c0000
    s_mov_b32 s31, 0x20000
    s_mov_b32 s32, s6
    s_and_b32 s33, s7, 0xffff
    s_mov_b32 s34, 0x126000
    s_mov_b32 s35, 0x20000
    v_add_u32 v4, v4, v8
    v_add_u32 v5, v5, v9
    v_add_u32 v6, v6, v10
    v_add_u32 v7, v7, v11
    s_lshl_b32 s50, s41, 7
    s_lshr_b32 s3, s48, 1
    s_lshl_b32 s3, s3, 6
    s_add_u32 s50, s50, s3
    s_and_b32 s3, s48, 1
    s_add_u32 s50, s50, s3
    s_mul_i32 s50, s50, 896
    s_add_u32 s42, s42, 2
    s_and_b32 s42, s42, 15
    s_mul_i32 s51, s42, 168
    s_andn2_b32 s51, s51, 15
    s_mul_i32 s3, s48, 43008
    s_add_u32 s51, s51, s3
H_NOSW:
    s_lshl_b32 s56, s49, 7
    s_add_u32 s56, s56, s50
    s_mul_i32 s57, s49, 172032
    s_add_u32 s57, s57, s51
    s_add_u32 s58, s54, s52
    s_add_u32 s59, s54, s53
    s_add_u32 m0, s58, 0
    s_nop 0
    buffer_load_dwordx4 v4, s[28:31], s56 offen lds
    s_add_u32 m0, s58, 1024
    s_nop 0
    buffer_load_dwordx4 v5, s[28:31], s56 offen lds
    s_add_u32 m0, s58, 2048
    s_nop 0
    buffer_load_dwordx4 v6, s[28:31], s56 offen lds
    s_add_u32 m0, s58, 3072
    s_nop 0
    buffer_load_dwordx4 v7, s[28:31], s56 offen lds
    s_add_u32 m0, s59, 0
    s_nop 0
    buffer_load_dwordx4 v12, s[32:35], s57 offen lds
    s_add_u32 m0, s59, 1024
    s_nop 0
    buffer_load_dwordx4 v13, s[32:35], s57 offen lds
    s_add_u32 m0, s59, 2048
    s_nop 0
    buffer_load_dwordx4 v14, s[32:35], s57 offen lds
    s_add_u32 s49, s49, 1
    s_cmp_eq_u32 s49, 7
    s_cselect_b32 s49, 0, s49
    s_add_u32 s54, s54, 28672
    s_cmp_eq_u32 s54, 143360
    s_cselect_b32 s54, 0, s54
    s_cmp_lg_u32 s55, 3
    s_cbranch_scc1 H_NOT3
    s_waitcnt lgkmcnt(0)
    s_mul_i32 s47, s47, 0x9e3779b1
    s_add_u32 s47, s47, 0x7f4a7c15
    v_mov_b32 v165, s47
H_NOT3:
    s_add_u32 s55, s55, 1
    s_cmp_lt_u32 s55, 14
    s_cbranch_scc1 H_GL
    s_waitcnt vmcnt(14)
    s_barrier
    s_lshl_b32 s50, s43, 18
    s_add_u32 s50, s50, 0x200000
    s_lshl_b32 s52, s48, 13
    s_add_u32 s50, s50, s52
    s_waitcnt vmcnt(7)
    s_barrier
    s_waitcnt vmcnt(0)
    s_barrier
    s_cmp_lg_u32 s48, 0
    s_cbranch_scc1 SG_1
    s_mov_b32 exec_lo, 0xffffffff
    s_mov_b32 exec_hi, 0xffff
    s_mov_b32 s62, 262144
GP_2:
    buffer_load_dword v19, v18, s[24:27], 0 offen sc1
    s_waitcnt vmcnt(0)
    v_cmp_ne_u32 vcc, s47, v19
    s_sub_u32 s62, s62, 1
    s_nop 3
    s_cbranch_vccz GP_2_OK
    s_sleep 1
    s_cmp_lg_u32 s62, 0
    s_cbranch_scc1 GP_2
GP_2_OK:
    s_mov_b64 exec, -1
    v_mov_b32 v162, 1
    ds_write_b32 v164, v162 offset:96
    s_branch SG_1_J
SG_1:
    s_mov_b32 s62, 4194304
LP_3:
    ds_read_b32 v144, v164 offset:96
    s_waitcnt lgkmcnt(0)
    v_cmp_gt_u32 vcc, 1, v144
    s_sub_u32 s62, s62, 1
    s_nop 3
    s_cbranch_vccz LP_3_OK
    s_sleep 1
    s_cmp_lg_u32 s62, 0
    s_cbranch_scc1 LP_3
LP_3_OK:
SG_1_J:
    s_lshl_b32 s56, s43, 6
    s_lshl_b32 s3, s44, 2
    s_add_u32 s56, s56, s3
    s_add_u32 s56, s56, s48
    s_lshl_b32 s56, s56, 11
    s_lshl_b32 s3, s48, 11
    s_add_u32 m0, s3, 143360
    s_nop 0
    buffer_load_dwordx4 v1, s[24:27], s56 offen offset:0 sc1 lds
    buffer_load_dwordx4 v1, s[24:27], s56 offen offset:1024 sc1 lds
    s_add_u32 s56, s44, 0
    s_and_b32 s56, s56, 7
    s_lshl_b32 s56, s56, 15
    s_add_u32 s56, s56, s50
    s_add_u32 s57, s56, 4096
    s_add_u32 m0, s52, 65536
    s_nop 0
    buffer_load_dwordx4 v1, s[24:27], s56 offen offset:0 sc1 lds
    buffer_load_dwordx4 v1, s[24:27], s56 offen offset:1024 sc1 lds
    buffer_load_dwordx4 v1, s[24:27], s56 offen offset:2048 sc1 lds
    buffer_load_dwordx4 v1, s[24:27], s56 offen offset:3072 sc1 lds
    s_add_u32 m0, s52, 69632
    s_nop 0
    buffer_load_dwordx4 v1, s[24:27], s57 offen offset:0 sc1 lds
    buffer_load_dwordx4 v1, s[24:27], s57 offen offset:1024 sc1 lds
    buffer_load_dwordx4 v1, s[24:27], s57 offen offset:2048 sc1 lds
    buffer_load_dwordx4 v1, s[24:27], s57 offen offset:3072 sc1 lds
H_FBJ:
    s_lshl_b32 s60, s44, 2
    s_add_u32 s60, s60, s48
    s_and_b32 s63, s60, 31
    v_add_u32 v18, 0x1000, v18
    s_lshl_b32 s61, s42, 7
    s_lshl_b32 s3, s41, 2
    s_add_u32 s61, s61, s3
    s_add_u32 s61, s61, 0x1002000
    v_lshrrev_b32 v20, 3, v0
    v_mul_u32_u24 v20, 896, v20
    v_and_b32 v19, 7, v0
    v_bfe_u32 v21, v0, 4, 1
    v_lshlrev_b32 v21, 2, v21
    v_xor_b32 v19, v19, v21
    v_lshl_add_u32 v20, v19, 4, v20
    s_mov_b32 s3, 0xff61b1e6
    v_mov_b32 v64, s3
    v_mov_b32 v65, s3
    v_mov_b32 v66, s3
    v_mov_b32 v67, s3
    v_mov_b32 v68, s3
    v_mov_b32 v69, s3
    v_mov_b32 v70, s3
    v_mov_b32 v71, s3
    v_mov_b32 v72, s3
    v_mov_b32 v73, s3
    v_mov_b32 v74, s3
    v_mov_b32 v75, s3
    v_mov_b32 v76, s3
    v_mov_b32 v77, s3
    v_mov_b32 v78, s3
    v_mov_b32 v79, s3
    v_mov_b32 v92, s3
    v_mov_b32 v93, s3
    v_mov_b32 v94, s3
    v_mov_b32 v95, s3
    v_mov_b32 v80, 0
    v_mov_b32 v81, 0
    v_mov_b32 v82, 0
    v_mov_b32 v83, 0
    v_mov_b32 v84, 0
    v_mov_b32 v85, 0
    v_mov_b32 v86, 0
    v_mov_b32 v87, 0
    v_mov_b32 v88, 0
    v_mov_b32 v89, 0
    v_mov_b32 v90, 0
    v_mov_b32 v91, 0
    s_mov_b32 exec_lo, 0xff
    s_mov_b32 exec_hi, 0xff0
    v_mov_b32 v64, 0
    s_mov_b32 exec_lo, 0x1fe
    s_mov_b32 exec_hi, 0x1fe0
    v_mov_b32 v65, 0
    s_mov_b32 exec_lo, 0x3fc
    s_mov_b32 exec_hi, 0x3fc0
    v_mov_b32 v66, 0
    s_mov_b32 exec_lo, 0x7f8
    s_mov_b32 exec_hi, 0x7f80
    v_mov_b32 v67, 0
    s_mov_b32 exec_lo, 0xff00
    s_mov_b32 exec_hi, 0xff000
    v_mov_b32 v68, 0
    s_mov_b32 exec_lo, 0x1fe00
    s_mov_b32 exec_hi, 0x1fe000
    v_mov_b32 v69, 0
    s_mov_b32 exec_lo, 0x3fc00
    s_mov_b32 exec_hi, 0x3fc000
    v_mov_b32 v70, 0
    s_mov_b32 exec_lo, 0x7f800
    s_mov_b32 exec_hi, 0x7f8000
    v_mov_b32 v71, 0
    s_mov_b32 exec_lo, 0xff0000
    s_mov_b32 exec_hi, 0xff00000
    v_mov_b32 v72, 0
    s_mov_b32 exec_lo, 0x1fe0000
    s_mov_b32 exec_hi, 0x1fe00000
    v_mov_b32 v73, 0
    s_mov_b32 exec_lo, 0x3fc0000
    s_mov_b32 exec_hi, 0x3fc00000
    v_mov_b32 v74, 0
    s_mov_b32 exec_lo, 0x7f80000
    s_mov_b32 exec_hi, 0x7f800000
    v_mov_b32 v75, 0
    s_mov_b32 exec_lo, 0xff000000
    s_mov_b32 exec_hi, 0xf0000000
    v_mov_b32 v76, 0
    s_mov_b32 exec_lo, 0xfe000000
    s_mov_b32 exec_hi, 0xe0000000
    v_mov_b32 v77, 0
    s_mov_b32 exec_lo, 0xfc000000
    s_mov_b32 exec_hi, 0xc0000000
    v_mov_b32 v78, 0
    s_mov_b32 exec_lo, 0xf8000000
    s_mov_b32 exec_hi, 0x80000000
    v_mov_b32 v79, 0
    s_cmp_eq_u32 s63, 0
    s_cbranch_scc1 H_NOPREV
    s_mov_b32 exec_lo, 0x0
    s_mov_b32 exec_hi, 0xf
    v_mov_b32 v92, 0
    s_mov_b32 exec_lo, 0x1
    s_mov_b32 exec_hi, 0x1f
    v_mov_b32 v93, 0
    s_mov_b32 exec_lo, 0x3
    s_mov_b32 exec_hi, 0x3f
    v_mov_b32 v94, 0
    s_mov_b32 exec_lo, 0x7
    s_mov_b32 exec_hi, 0x7f
    v_mov_b32 v95, 0
H_NOPREV:
    s_mov_b64 exec, -1
    s_mov_b32 s28, s14
    s_and_b32 s29, s15, 0xffff
    s_mov_b32 s30, 0x62000
    s_mov_b32 s31, 0x20000
    s_mov_b32 s32, s8
    s_and_b32 s33, s9, 0xffff
    s_mov_b32 s34, 0x62000
    s_mov_b32 s35, 0x20000
    s_mul_i32 s51, s48, 57344
    s_min_u32 s3, s46, 6
    s_lshl_b32 s3, s3, 7
    s_add_u32 s51, s51, s3
    s_waitcnt vmcnt(0)
    s_barrier
    s_add_u32 s56, s44, 1
    s_and_b32 s56, s56, 7
    s_lshl_b32 s56, s56, 15
    s_add_u32 s56, s56, s50
    s_add_u32 s57, s56, 4096
    s_add_u32 m0, s52, 98304
    s_nop 0
    buffer_load_dwordx4 v1, s[24:27], s56 offen offset:0 sc1 lds
    buffer_load_dwordx4 v1, s[24:27], s56 offen offset:1024 sc1 lds
    buffer_load_dwordx4 v1, s[24:27], s56 offen offset:2048 sc1 lds
    buffer_load_dwordx4 v1, s[24:27], s56 offen offset:3072 sc1 lds
    s_add_u32 m0, s52, 102400
    s_nop 0
    buffer_load_dwordx4 v1, s[24:27], s57 offen offset:0 sc1 lds
    buffer_load_dwordx4 v1, s[24:27], s57 offen offset:1024 sc1 lds
    buffer_load_dwordx4 v1, s[24:27], s57 offen offset:2048 sc1 lds
    buffer_load_dwordx4 v1, s[24:27], s57 offen offset:3072 sc1 lds
    s_add_u32 s56, s44, 2
    s_and_b32 s56, s56, 7
    s_lshl_b32 s56, s56, 15
    s_add_u32 s56, s56, s50
    s_add_u32 s57, s56, 4096
    s_add_u32 m0, s52, 0
    s_nop 0
    buffer_load_dwordx4 v1, s[24:27], s56 offen offset:0 sc1 lds
    buffer_load_dwordx4 v1, s[24:27], s56 offen offset:1024 sc1 lds
    buffer_load_dwordx4 v1, s[24:27], s56 offen offset:2048 sc1 lds
    buffer_load_dwordx4 v1, s[24:27], s56 offen offset:3072 sc1 lds
    s_add_u32 m0, s52, 4096
    s_nop 0
    buffer_load_dwordx4 v1, s[24:27], s57 offen offset:0 sc1 lds
    buffer_load_dwordx4 v1, s[24:27], s57 offen offset:1024 sc1 lds
    buffer_load_dwordx4 v1, s[24:27], s57 offen offset:2048 sc1 lds
    buffer_load_dwordx4 v1, s[24:27], s57 offen offset:3072 sc1 lds
    s_waitcnt vmcnt(8)
    s_barrier
    s_add_u32 s56, s44, 3
    s_and_b32 s56, s56, 7
    s_lshl_b32 s56, s56, 15
    s_add_u32 s56, s56, s50
    s_add_u32 s57, s56, 4096
    s_add_u32 m0, s52, 32768
    s_nop 0
    buffer_load_dwordx4 v1, s[24:27], s56 offen offset:0 sc1 lds
    buffer_load_dwordx4 v1, s[24:27], s56 offen offset:1024 sc1 lds
    buffer_load_dwordx4 v1, s[24:27], s56 offen offset:2048 sc1 lds
    buffer_load_dwordx4 v1, s[24:27], s56 offen offset:3072 sc1 lds
    s_add_u32 m0, s52, 36864
    s_nop 0
    buffer_load_dwordx4 v1, s[24:27], s57 offen offset:0 sc1 lds
    buffer_load_dwordx4 v1, s[24:27], s57 offen offset:1024 sc1 lds
    buffer_load_dwordx4 v1, s[24:27], s57 offen offset:2048 sc1 lds
    buffer_load_dwordx4 v1, s[24:27], s57 offen offset:3072 sc1 lds
    s_cmp_lg_u32 s48, 0
    s_cbranch_scc1 H_NOFA
    s_mov_b64 exec, 1
    buffer_store_dword v165, v166, s[24:27], s61 offen sc1
    s_mov_b64 exec, -1
H_NOFA:
    s_waitcnt vmcnt(8)
    s_barrier
    s_add_u32 s56, s44, 4
    s_and_b32 s56, s56, 7
    s_lshl_b32 s56, s56, 15
    s_add_u32 s56, s56, s50
    s_add_u32 s57, s56, 4096
    s_add_u32 m0, s52, 65536
    s_nop 0
    buffer_load_dwordx4 v1, s[24:27], s56 offen offset:0 sc1 lds
    buffer_load_dwordx4 v1, s[24:27], s56 offen offset:1024 sc1 lds
    buffer_load_dwordx4 v1, s[24:27], s56 offen offset:2048 sc1 lds
    buffer_load_dwordx4 v1, s[24:27], s56 offen offset:3072 sc1 lds
    s_add_u32 m0, s52, 69632
    s_nop 0
    buffer_load_dwordx4 v1, s[24:27], s57 offen offset:0 sc1 lds
    buffer_load_dwordx4 v1, s[24:27], s57 offen offset:1024 sc1 lds
    buffer_load_dwordx4 v1, s[24:27], s57 offen offset:2048 sc1 lds
    buffer_load_dwordx4 v1, s[24:27], s57 offen offset:3072 sc1 lds
    s_add_u32 s56, s51, 200704
    s_add_u32 m0, s52, 131072
    s_nop 0
    buffer_load_dwordx4 v20, s[32:35], s56 offen lds
    s_add_u32 s56, s51, 207872
    s_add_u32 m0, s52, 132096
    s_nop 0
    buffer_load_dwordx4 v20, s[32:35], s56 offen lds
    s_add_u32 s56, s51, 215040
    s_add_u32 m0, s52, 133120
    s_nop 0
    buffer_load_dwordx4 v20, s[32:35], s56 offen lds
    s_add_u32 s56, s51, 222208
    s_add_u32 m0, s52, 134144
    s_nop 0
    buffer_load_dwordx4 v20, s[32:35], s56 offen lds
    s_add_u32 s56, s51, 229376
    s_add_u32 m0, s52, 135168
    s_nop 0
    buffer_load_dwordx4 v20, s[32:35], s56 offen lds
    s_cmp_eq_u32 s48, 3
    s_cbranch_scc1 H_WA3
    s_add_u32 s56, s51, 236544
    s_add_u32 m0, s52, 136192
    s_nop 0
    buffer_load_dwordx4 v20, s[32:35], s56 offen lds
    s_add_u32 s56, s51, 243712
    s_add_u32 m0, s52, 137216
    s_nop 0
    buffer_load_dwordx4 v20, s[32:35], s56 offen lds
    s_add_u32 s56, s51, 250880
    s_add_u32 m0, s52, 138240
    s_nop 0
    buffer_load_dwordx4 v20, s[32:35], s56 offen lds
H_WA3:
    s_waitcnt vmcnt(8)
    s_barrier
    s_add_u32 s56, s44, 5
    s_and_b32 s56, s56, 7
    s_lshl_b32 s56, s56, 15
    s_add_u32 s56, s56, s50
    s_add_u32 s57, s56, 4096
    s_add_u32 m0, s52, 98304
    s_nop 0
    buffer_load_dwordx4 v1, s[24:27], s56 offen offset:0 sc1 lds
    buffer_load_dwordx4 v1, s[24:27], s56 offen offset:1024 sc1 lds
    buffer_load_dwordx4 v1, s[24:27], s56 offen offset:2048 sc1 lds
    buffer_load_dwordx4 v1, s[24:27], s56 offen offset:3072 sc1 lds
    s_add_u32 m0, s52, 102400
    s_nop 0
    buffer_load_dwordx4 v1, s[24:27], s57 offen offset:0 sc1 lds
    buffer_load_dwordx4 v1, s[24:27], s57 offen offset:1024 sc1 lds
    buffer_load_dwordx4 v1, s[24:27], s57 offen offset:2048 sc1 lds
    buffer_load_dwordx4 v1, s[24:27], s57 offen offset:3072 sc1 lds
    s_waitcnt vmcnt(8)
    s_barrier
    s_add_u32 s56, s44, 6
    s_and_b32 s56, s56, 7
    s_lshl_b32 s56, s56, 15
    s_add_u32 s56, s56, s50
    s_add_u32 s57, s56, 4096
    s_add_u32 m0, s52, 0
    s_nop 0
    buffer_load_dwordx4 v1, s[24:27], s56 offen offset:0 sc1 lds
    buffer_load_dwordx4 v1, s[24:27], s56 offen offset:1024 sc1 lds
    buffer_load_dwordx4 v1, s[24:27], s56 offen offset:2048 sc1 lds
    buffer_load_dwordx4 v1, s[24:27], s56 offen offset:3072 sc1 lds
    s_add_u32 m0, s52, 4096
    s_nop 0
    buffer_load_dwordx4 v1, s[24:27], s57 offen offset:0 sc1 lds
    buffer_load_dwordx4 v1, s[24:27], s57 offen offset:1024 sc1 lds
    buffer_load_dwordx4 v1, s[24:27], s57 offen offset:2048 sc1 lds
    buffer_load_dwordx4 v1, s[24:27], s57 offen offset:3072 sc1 lds
    s_cmp_lg_u32 s48, 0
    s_cbranch_scc1 SG_4
    s_mov_b32 exec_lo, 0xffffffff
    s_mov_b32 exec_hi, 0xffff
    s_mov_b32 s62, 262144
GP_5:
    buffer_load_dword v19, v18, s[24:27], 0 offen sc1
    s_waitcnt vmcnt(0)
    v_cmp_ne_u32 vcc, s47, v19
    s_sub_u32 s62, s62, 1
    s_nop 3
    s_cbranch_vccz GP_5_OK
    s_sleep 2
    s_cmp_lg_u32 s62, 0
    s_cbranch_scc1 GP_5
GP_5_OK:
    s_mov_b64 exec, -1
    v_mov_b32 v162, 1
    ds_write_b32 v164, v162 offset:100
    s_branch SG_4_J
SG_4:
    s_mov_b32 s62, 4194304
LP_6:
    ds_read_b32 v144, v164 offset:100
    s_waitcnt lgkmcnt(0)
    v_cmp_gt_u32 vcc, 1, v144
    s_sub_u32 s62, s62, 1
    s_nop 3
    s_cbranch_vccz LP_6_OK
    s_sleep 2
    s_cmp_lg_u32 s62, 0
    s_cbranch_scc1 LP_6
LP_6_OK:
SG_4_J:
    s_waitcnt vmcnt(8)
    s_lshl_b32 s3, s43, 6
    s_add_u32 s3, s3, s60
    s_lshl_b32 s57, s3, 11
    s_add_u32 s57, s57, 0x600000
    s_lshl_b32 s58, s3, 12
    s_add_u32 s58, s58, 0x800000
    s_sub_u32 s59, s58, 4096
    s_cmp_eq_u32 s63, 0
    s_cselect_b32 s59, s58, s59
    buffer_load_dwordx4 v[24:27], v1, s[24:27], s57 offen offset:0 sc1
    buffer_load_dwordx4 v[28:31], v1, s[24:27], s57 offen offset:1024 sc1
    buffer_load_dwordx4 v[32:35], v1, s[24:27], s58 offen offset:0 sc1
    buffer_load_dwordx4 v[36:39], v1, s[24:27], s58 offen offset:1024 sc1
    buffer_load_dwordx4 v[48:51], v1, s[24:27], s59 offen offset:0 sc1
    buffer_load_dwordx4 v[52:55], v1, s[24:27], s59 offen offset:1024 sc1
    buffer_load_dwordx4 v[40:43], v1, s[24:27], s58 offen offset:2048 sc1
    buffer_load_dwordx4 v[44:47], v1, s[24:27], s58 offen offset:3072 sc1
    buffer_load_dwordx4 v[56:59], v1, s[24:27], s59 offen offset:3072 sc1
    s_barrier
    s_add_u32 s56, s44, 7
    s_and_b32 s56, s56, 7
    s_lshl_b32 s56, s56, 15
    s_add_u32 s56, s56, s50
    s_add_u32 s57, s56, 4096
    s_add_u32 m0, s52, 32768
    s_nop 0
    buffer_load_dwordx4 v1, s[24:27], s56 offen offset:0 sc1 lds
    buffer_load_dwordx4 v1, s[24:27], s56 offen offset:1024 sc1 lds
    buffer_load_dwordx4 v1, s[24:27], s56 offen offset:2048 sc1 lds
    buffer_load_dwordx4 v1, s[24:27], s56 offen offset:3072 sc1 lds
    s_add_u32 m0, s52, 36864
    s_nop 0
    buffer_load_dwordx4 v1, s[24:27], s57 offen offset:0 sc1 lds
    buffer_load_dwordx4 v1, s[24:27], s57 offen offset:1024 sc1 lds
    buffer_load_dwordx4 v1, s[24:27], s57 offen offset:2048 sc1 lds
    buffer_load_dwordx4 v1, s[24:27], s57 offen offset:3072 sc1 lds
    s_waitcnt vmcnt(11)
    v_mfma_f32_32x32x16_bf16 v[64:79], v[32:35], v[24:27], v[64:79]
    v_mfma_f32_32x32x16_bf16 v[80:95], v[48:51], v[24:27], v[80:95]
    v_mfma_f32_32x32x16_bf16 v[64:79], v[36:39], v[28:31], v[64:79]
    v_mfma_f32_32x32x16_bf16 v[80:95], v[52:55], v[28:31], v[80:95]
    s_nop 15
    s_nop 3
    v_max3_f32 v124, v64, v65, v66
    v_max3_f32 v124, v124, v67, v68
    v_max3_f32 v124, v124, v69, v70
    v_max3_f32 v124, v124, v71, v72
    v_max3_f32 v124, v124, v73, v74
    v_max3_f32 v124, v124, v75, v76
    v_max3_f32 v124, v124, v77, v78
    v_max3_f32 v124, v124, v79, v92
    v_max3_f32 v124, v124, v93, v94
    v_max_f32 v124, v124, v95
    v_mov_b32 v125, v124
    s_nop 1
    v_permlane32_swap_b32 v124, v125
    s_nop 1
    v_max_f32 v124, v124, v125
    v_sub_f32 v64, v64, v124
    v_sub_f32 v65, v65, v124
    v_sub_f32 v66, v66, v124
    v_sub_f32 v67, v67, v124
    v_sub_f32 v68, v68, v124
    v_sub_f32 v69, v69, v124
    v_sub_f32 v70, v70, v124
    v_sub_f32 v71, v71, v124
    v_sub_f32 v72, v72, v124
    v_sub_f32 v73, v73, v124
    v_sub_f32 v74, v74, v124
    v_sub_f32 v75, v75, v124
    v_sub_f32 v76, v76, v124
    v_sub_f32 v77, v77, v124
    v_sub_f32 v78, v78, v124
    v_sub_f32 v79, v79, v124
    v_sub_f32 v92, v92, v124
    v_sub_f32 v93, v93, v124
    v_sub_f32 v94, v94, v124
    v_sub_f32 v95, v95, v124
    v_exp_f32 v64, v64
    v_exp_f32 v65, v65
    v_exp_f32 v66, v66
    v_exp_f32 v67, v67
    v_exp_f32 v68, v68
    v_exp_f32 v69, v69
    v_exp_f32 v70, v70
    v_exp_f32 v71, v71
    v_exp_f32 v72, v72
    v_exp_f32 v73, v73
    v_exp_f32 v74, v74
    v_exp_f32 v75, v75
    v_exp_f32 v76, v76
    v_exp_f32 v77, v77
    v_exp_f32 v78, v78
    v_exp_f32 v79, v79
    v_exp_f32 v92, v92
    v_exp_f32 v93, v93
    v_exp_f32 v94, v94
    v_exp_f32 v95, v95
    s_nop 0
    v_cvt_pk_bf16_f32 v112, v64, v65
    v_cvt_pk_bf16_f32 v113, v66, v67
    v_cvt_pk_bf16_f32 v114, v68, v69
    v_cvt_pk_bf16_f32 v115, v70, v71
    v_cvt_pk_bf16_f32 v116, v72, v73
    v_cvt_pk_bf16_f32 v117, v74, v75
    v_cvt_pk_bf16_f32 v118, v76, v77
    v_cvt_pk_bf16_f32 v119, v78, v79
    v_mov_b32 v120, 0
    v_mov_b32 v121, 0
    v_cvt_pk_bf16_f32 v122, v92, v93
    v_cvt_pk_bf16_f32 v123, v94, v95
    s_waitcnt vmcnt(8)
    s_nop 0
    v_mfma_f32_32x32x16_bf16 v[96:111], v[40:43], v[112:115], 0
    v_mfma_f32_32x32x16_bf16 v[96:111], v[44:47], v[116:119], v[96:111]
    v_mfma_f32_32x32x16_bf16 v[96:111], v[56:59], v[120:123], v[96:111]
    s_nop 15
    s_nop 3
    v_mov_b32 v124, v108
    v_mov_b32 v125, v108
    s_nop 1
    v_permlane32_swap_b32 v124, v125
    s_nop 1
    v_rcp_f32 v125, v125
    s_nop 0
    v_mul_f32 v96, v96, v125
    v_mul_f32 v97, v97, v125
    v_mul_f32 v98, v98, v125
    v_mul_f32 v99, v99, v125
    v_mul_f32 v100, v100, v125
    v_mul_f32 v101, v101, v125
    v_mul_f32 v102, v102, v125
    v_mul_f32 v103, v103, v125
    v_mul_f32 v104, v104, v125
    v_mul_f32 v105, v105, v125
    v_mul_f32 v106, v106, v125
    v_mul_f32 v107, v107, v125
    v_mul_f32 v108, v108, v125
    v_mul_f32 v109, v109, v125
    v_mul_f32 v110, v110, v125
    v_mul_f32 v111, v111, v125
    v_cvt_pk_bf16_f32 v112, v96, v97
    v_cvt_pk_bf16_f32 v113, v98, v99
    v_cvt_pk_bf16_f32 v114, v100, v101
    v_cvt_pk_bf16_f32 v115, v102, v103
    v_cvt_pk_bf16_f32 v116, v104, v105
    v_cvt_pk_bf16_f32 v117, v106, v107
    v_cvt_pk_bf16_f32 v118, v108, v109
    v_cvt_pk_bf16_f32 v119, v110, v111
    s_mov_b32 exec_lo, 0
    v_mov_b32 v118, 0
    v_mov_b32 v119, 0
    s_mov_b32 exec_lo, -1
    s_lshl_b32 s57, s60, 4
    s_add_u32 s57, s57, s43
    s_lshl_b32 s57, s57, 11
    s_add_u32 s57, s57, 0xc00000
    buffer_store_dwordx4 v[112:115], v1, s[24:27], s57 offen sc1
    buffer_store_dwordx4 v[116:119], v1, s[24:27], s57 offen offset:1024 sc1
    s_lshl_b32 s3, s63, 7
    s_lshr_b32 s58, s60, 5
    s_lshl_b32 s58, s58, 4
    s_add_u32 s58, s58, s43
    s_lshl_b32 s58, s58, 2
    s_add_u32 s58, s58, s3
    s_add_u32 s58, s58, 0x1003000
    s_barrier
    s_waitcnt vmcnt(0)
    s_mov_b64 exec, 1
    buffer_store_dword v165, v166, s[24:27], s58 offen sc1
    s_mov_b64 exec, -1
    s_cmp_ge_u32 s2, 224
    s_cbranch_scc1 H_NOPROJ
    s_lshl_b32 s3, s45, 7
    s_add_u32 s3, s3, 0x1003000
    v_lshlrev_b32 v18, 2, v0
    v_add_u32 v18, s3, v18
    s_add_u32 s56, s51, 0
    s_add_u32 m0, s52, 65536
    s_nop 0
    buffer_load_dwordx4 v20, s[28:31], s56 offen lds
    s_add_u32 s56, s51, 7168
    s_add_u32 m0, s52, 66560
    s_nop 0
    buffer_load_dwordx4 v20, s[28:31], s56 offen lds
    s_add_u32 s56, s51, 14336
    s_add_u32 m0, s52, 67584
    s_nop 0
    buffer_load_dwordx4 v20, s[28:31], s56 offen lds
    s_add_u32 s56, s51, 21504
    s_add_u32 m0, s52, 68608
    s_nop 0
    buffer_load_dwordx4 v20, s[28:31], s56 offen lds
    s_add_u32 s56, s51, 28672
    s_add_u32 m0, s52, 69632
    s_nop 0
    buffer_load_dwordx4 v20, s[28:31], s56 offen lds
    s_add_u32 s56, s51, 35840
    s_add_u32 m0, s52, 70656
    s_nop 0
    buffer_load_dwordx4 v20, s[28:31], s56 offen lds
    s_add_u32 s56, s51, 43008
    s_add_u32 m0, s52, 71680
    s_nop 0
    buffer_load_dwordx4 v20, s[28:31], s56 offen lds
    s_add_u32 s56, s51, 50176
    s_add_u32 m0, s52, 72704
    s_nop 0
    buffer_load_dwordx4 v20, s[28:31], s56 offen lds
    s_barrier
    s_add_u32 s56, s51, 229376
    s_add_u32 m0, s52, 98304
    s_nop 0
    buffer_load_dwordx4 v20, s[28:31], s56 offen lds
    s_add_u32 s56, s51, 236544
    s_add_u32 m0, s52, 99328
    s_nop 0
    buffer_load_dwordx4 v20, s[28:31], s56 offen lds
    s_add_u32 s56, s51, 243712
    s_add_u32 m0, s52, 100352
    s_nop 0
    buffer_load_dwordx4 v20, s[28:31], s56 offen lds
    s_add_u32 s56, s51, 250880
    s_add_u32 m0, s52, 101376
    s_nop 0
    buffer_load_dwordx4 v20, s[28:31], s56 offen lds
    s_add_u32 s56, s51, 258048
    s_add_u32 m0, s52, 102400
    s_nop 0
    buffer_load_dwordx4 v20, s[28:31], s56 offen lds
    s_add_u32 s56, s51, 265216
    s_add_u32 m0, s52, 103424
    s_nop 0
    buffer_load_dwordx4 v20, s[28:31], s56 offen lds
    s_add_u32 s56, s51, 272384
    s_add_u32 m0, s52, 104448
    s_nop 0
    buffer_load_dwordx4 v20, s[28:31], s56 offen lds
    s_add_u32 s56, s51, 279552
    s_add_u32 m0, s52, 105472
    s_nop 0
    buffer_load_dwordx4 v20, s[28:31], s56 offen lds
    s_cmp_lg_u32 s48, 0
    s_cbranch_scc1 SG_7
    s_mov_b32 exec_lo, 0xffffffff
    s_mov_b32 exec_hi, 0x0
    s_mov_b32 s62, 262144
GP_8:
    buffer_load_dword v19, v18, s[24:27], 0 offen sc1
    s_waitcnt vmcnt(0)
    v_cmp_ne_u32 vcc, s47, v19
    s_sub_u32 s62, s62, 1
    s_nop 3
    s_cbranch_vccz GP_8_OK
    s_sleep 2
    s_cmp_lg_u32 s62, 0
    s_cbranch_scc1 GP_8
GP_8_OK:
    s_mov_b64 exec, -1
    v_mov_b32 v162, 1
    ds_write_b32 v164, v162 offset:104
    s_branch SG_7_J
SG_7:
    s_mov_b32 s62, 4194304
LP_9:
    ds_read_b32 v144, v164 offset:104
    s_waitcnt lgkmcnt(0)
    v_cmp_gt_u32 vcc, 1, v144
    s_sub_u32 s62, s62, 1
    s_nop 3
    s_cbranch_vccz LP_9_OK
    s_sleep 2
    s_cmp_lg_u32 s62, 0
    s_cbranch_scc1 LP_9
LP_9_OK:
SG_7_J:
    s_barrier
    s_add_u32 s56, s51, 0
    s_add_u32 m0, s52, 0
    s_nop 0
    buffer_load_dwordx4 v20, s[32:35], s56 offen lds
    s_add_u32 s56, s51, 7168
    s_add_u32 m0, s52, 1024
    s_nop 0
    buffer_load_dwordx4 v20, s[32:35], s56 offen lds
    s_add_u32 s56, s51, 14336
    s_add_u32 m0, s52, 2048
    s_nop 0
    buffer_load_dwordx4 v20, s[32:35], s56 offen lds
    s_add_u32 s56, s51, 21504
    s_add_u32 m0, s52, 3072
    s_nop 0
    buffer_load_dwordx4 v20, s[32:35], s56 offen lds
    s_add_u32 s56, s51, 28672
    s_add_u32 m0, s52, 4096
    s_nop 0
    buffer_load_dwordx4 v20, s[32:35], s56 offen lds
    s_add_u32 s56, s51, 35840
    s_add_u32 m0, s52, 5120
    s_nop 0
    buffer_load_dwordx4 v20, s[32:35], s56 offen lds
    s_add_u32 s56, s51, 43008
    s_add_u32 m0, s52, 6144
    s_nop 0
    buffer_load_dwordx4 v20, s[32:35], s56 offen lds
    s_add_u32 s56, s51, 50176
    s_add_u32 m0, s52, 7168
    s_nop 0
    buffer_load_dwordx4 v20, s[32:35], s56 offen lds
    s_waitcnt vmcnt(0)
    s_barrier
    s_branch H_DONE
H_NOPROJ:
    s_barrier
    s_barrier
    s_barrier
H_DONE:
    s_endpgm
L_COMPUTE:
    s_and_b32 s48, s40, 3
    s_lshr_b32 s49, s40, 2
    s_cmp_lg_u32 s40, 0
    s_cbranch_scc1 C_NOZ
    v_lshlrev_b32 v2, 2, v0
    v_add_u32 v2, 0x27f00, v2
    v_mov_b32 v3, 0
    ds_write_b32 v2, v3
C_NOZ:
    s_sub_u32 s3, s40, 1
    s_cmp_gt_u32 s3, 1
    s_cbranch_scc1 C_NOCPF
    s_getpc_b64 s[56:57]
C_PCREF:
    s_lshl_b32 s3, s3, 13
    v_lshlrev_b32 v2, 7, v0
    v_add_u32 v2, s3, v2
    v_min_u32 v2, L_END-concat_heads__sliding_local_dilated__softmax_full_mha__prompt_kernel, v2
    s_sub_u32 s56, s56, C_PCREF-concat_heads__sliding_local_dilated__softmax_full_mha__prompt_kernel
    s_subb_u32 s57, s57, 0
    v_mov_b32 v3, s57
    v_add_co_u32 v2, vcc, s56, v2
    s_nop 1
    v_addc_co_u32 v3, vcc, 0, v3, vcc
    global_load_dword v160, v[2:3], off
C_NOCPF:
    s_waitcnt lgkmcnt(0)
    s_and_b32 s43, s2, 15
    s_lshr_b32 s44, s2, 4
    s_and_b32 s45, s2, 7
    s_lshl_b32 s45, s45, 2
    s_bfe_u32 s3, s2, 0x20003
    s_add_u32 s45, s45, s3
    s_lshr_b32 s46, s2, 5
    v_mov_b32 v164, 0x27f00
    v_mov_b32 v166, 0
    s_add_u32 s22, s20, 0x1000000
    s_addc_u32 s23, s21, 0
    s_load_dword s47, s[22:23], 0
    s_mov_b32 s24, s20
    s_and_b32 s25, s21, 0xffff
    s_mov_b32 s26, 0x1020000
    s_mov_b32 s27, 0x20000
    s_lshl_b32 s57, s44, 2
    s_add_u32 s57, s57, s48
    s_lshl_b32 s57, s57, 4
    s_add_u32 s57, s57, s43
    s_lshl_b32 s57, s57, 1
    s_add_u32 s57, s57, s49
    s_lshl_b32 s57, s57, 10
    s_add_u32 s57, s57, 0xe00000
    v_mov_b32 v152, -1
    v_mov_b32 v153, -1
    v_mov_b32 v154, -1
    v_mov_b32 v155, -1
    buffer_store_dwordx4 v[152:155], v1, s[24:27], s57 offen sc1
    s_lshl_b32 s3, s40, 2
    s_add_u32 s3, s3, 0x27f10
    v_mov_b32 v163, s3
    v_mov_b32 v162, 0
    v_and_b32 v16, 31, v0
    s_lshl_b32 s3, s48, 5
    v_add_u32 v16, s3, v16
    v_bfe_u32 v17, v16, 1, 3
    v_lshrrev_b32 v18, 5, v0
    v_lshlrev_b32 v16, 7, v16
    v_or_b32 v19, 0, v18
    v_xor_b32 v19, v19, v17
    v_lshl_add_u32 v2, v19, 4, v16
    v_or_b32 v19, 2, v18
    v_xor_b32 v19, v19, v17
    v_lshl_add_u32 v3, v19, 4, v16
    v_or_b32 v19, 4, v18
    v_xor_b32 v19, v19, v17
    v_lshl_add_u32 v4, v19, 4, v16
    v_or_b32 v19, 6, v18
    v_xor_b32 v19, v19, v17
    v_lshl_add_u32 v5, v19, 4, v16
    v_bfe_u32 v19, v0, 2, 2
    v_lshl_add_u32 v19, v18, 3, v19
    v_mul_u32_u24 v19, 192, v19
    v_bfe_u32 v20, v0, 4, 1
    v_lshl_add_u32 v19, v20, 5, v19
    v_and_b32 v20, 3, v0
    v_lshl_add_u32 v19, v20, 3, v19
    s_and_b32 s3, s42, 1
    s_lshl_b32 s3, s3, 3
    s_mul_i32 s54, s49, 112
    s_add_u32 s3, s3, s54
    s_add_u32 s3, s3, 16384
    v_add_u32 v6, s3, v19
    s_mov_b32 s61, 57344
    s_mul_i32 s54, s42, 3
    s_lshl_b32 s3, s49, 1
    s_add_u32 s54, s54, s3
    s_lshl_b32 s51, s41, 2
    s_add_u32 s51, s51, s48
    s_mov_b32 s52, 0x0
    s_mov_b32 s53, 0x200000
    s_mov_b32 s50, 0
    s_lshl_b32 s63, s42, 7
    s_lshl_b32 s3, s41, 2
    s_add_u32 s63, s63, s3
    v_mov_b32 v120, 0
    v_mov_b32 v121, 0
    v_mov_b32 v122, 0
    v_mov_b32 v123, 0
    v_mov_b32 v124, 0
    v_mov_b32 v125, 0
    v_mov_b32 v126, 0
    v_mov_b32 v127, 0
    v_mov_b32 v128, 0
    v_mov_b32 v129, 0
    v_mov_b32 v130, 0
    v_mov_b32 v131, 0
    v_mov_b32 v132, 0
    v_mov_b32 v133, 0
    v_mov_b32 v134, 0
    v_mov_b32 v135, 0
    v_mov_b32 v136, 0
    v_mov_b32 v137, 0
    v_mov_b32 v138, 0
    v_mov_b32 v139, 0
    v_mov_b32 v140, 0
    v_mov_b32 v141, 0
    v_mov_b32 v142, 0
    v_mov_b32 v143, 0
    v_mov_b32 v144, 0
    v_mov_b32 v145, 0
    v_mov_b32 v146, 0
    v_mov_b32 v147, 0
    v_mov_b32 v148, 0
    v_mov_b32 v149, 0
    v_mov_b32 v150, 0
    v_mov_b32 v151, 0
    v_mov_b32 v72, 0
    v_mov_b32 v73, 0
    v_mov_b32 v74, 0
    v_mov_b32 v75, 0
    v_mov_b32 v76, 0
    v_mov_b32 v77, 0
    v_mov_b32 v78, 0
    v_mov_b32 v79, 0
    v_mov_b32 v80, 0
    v_mov_b32 v81, 0
    v_mov_b32 v82, 0
    v_mov_b32 v83, 0
    v_mov_b32 v84, 0
    v_mov_b32 v85, 0
    v_mov_b32 v86, 0
    v_mov_b32 v87, 0
    v_mov_b32 v88, 0
    v_mov_b32 v89, 0
    v_mov_b32 v90, 0
    v_mov_b32 v91, 0
    v_mov_b32 v92, 0
    v_mov_b32 v93, 0
    v_mov_b32 v94, 0
    v_mov_b32 v95, 0
    v_mov_b32 v96, 0
    v_mov_b32 v97, 0
    v_mov_b32 v98, 0
    v_mov_b32 v99, 0
    v_mov_b32 v100, 0
    v_mov_b32 v101, 0
    v_mov_b32 v102, 0
    v_mov_b32 v103, 0
    v_mov_b32 v104, 0
    v_mov_b32 v105, 0
    v_mov_b32 v106, 0
    v_mov_b32 v107, 0
    v_mov_b32 v108, 0
    v_mov_b32 v109, 0
    v_mov_b32 v110, 0
    v_mov_b32 v111, 0
    v_mov_b32 v112, 0
    v_mov_b32 v113, 0
    v_mov_b32 v114, 0
    v_mov_b32 v115, 0
    v_mov_b32 v116, 0
    v_mov_b32 v117, 0
    v_mov_b32 v118, 0
    v_mov_b32 v119, 0
    v_add_u32 v8, s61, v2
    v_add_u32 v9, s61, v3
    v_add_u32 v10, s61, v4
    v_add_u32 v11, s61, v5
    v_add_u32 v12, s61, v6
    s_add_u32 s61, s61, 28672
    s_cmp_eq_u32 s61, 143360
    s_cselect_b32 s61, 0, s61
    v_add_u32 v162, 1, v162
    s_waitcnt lgkmcnt(0)
    s_mul_i32 s47, s47, 0x9e3779b1
    s_add_u32 s47, s47, 0x7f4a7c15
    v_mov_b32 v165, s47
    s_cmp_eq_u32 s49, 0
    s_cbranch_scc0 C_SEL1
    s_cmp_le_u32 s42, 10
    s_cbranch_scc1 C_G_TT_LOOP
    s_branch C_G_NN_LOOP
C_SEL1:
    s_cmp_le_u32 s42, 9
    s_cbranch_scc1 C_G_T_LOOP
    s_branch C_G_N_LOOP
C_G_TT_LOOP:
    s_barrier
    ds_read_b128 v[24:27], v8
    ds_read_b64_tr_b16 v[40:41], v12 offset:0
    ds_read_b64_tr_b16 v[42:43], v12 offset:768
    ds_read_b64_tr_b16 v[44:45], v12 offset:56
    ds_read_b64_tr_b16 v[46:47], v12 offset:824
    ds_read_b128 v[28:31], v9
    ds_read_b64_tr_b16 v[48:49], v12 offset:3072
    ds_read_b64_tr_b16 v[50:51], v12 offset:3840
    ds_read_b64_tr_b16 v[52:53], v12 offset:3128
    ds_read_b64_tr_b16 v[54:55], v12 offset:3896
    ds_read_b128 v[32:35], v10
    ds_read_b64_tr_b16 v[56:57], v12 offset:6144
    ds_read_b64_tr_b16 v[58:59], v12 offset:6912
    ds_read_b64_tr_b16 v[60:61], v12 offset:6200
    ds_read_b64_tr_b16 v[62:63], v12 offset:6968
    ds_read_b128 v[36:39], v11
    ds_read_b64_tr_b16 v[64:65], v12 offset:9216
    ds_read_b64_tr_b16 v[66:67], v12 offset:9984
    ds_read_b64_tr_b16 v[68:69], v12 offset:9272
    ds_read_b64_tr_b16 v[70:71], v12 offset:10040
    v_mfma_f32_32x32x16_bf16 v[120:135], v[88:91], v[72:75], v[120:135]
    v_mfma_f32_32x32x16_bf16 v[136:151], v[92:95], v[72:75], v[136:151]
    v_mfma_f32_32x32x16_bf16 v[120:135], v[96:99], v[76:79], v[120:135]
    v_mfma_f32_32x32x16_bf16 v[136:151], v[100:103], v[76:79], v[136:151]
    v_mfma_f32_32x32x16_bf16 v[120:135], v[104:107], v[80:83], v[120:135]
    v_mfma_f32_32x32x16_bf16 v[136:151], v[108:111], v[80:83], v[136:151]
    v_mfma_f32_32x32x16_bf16 v[120:135], v[112:115], v[84:87], v[120:135]
    v_mfma_f32_32x32x16_bf16 v[136:151], v[116:119], v[84:87], v[136:151]
    v_add_u32 v8, s61, v2
    v_add_u32 v9, s61, v3
    v_add_u32 v10, s61, v4
    v_add_u32 v11, s61, v5
    v_add_u32 v12, s61, v6
    s_add_u32 s61, s61, 28672
    s_cmp_eq_u32 s61, 143360
    s_cselect_b32 s61, 0, s61
    v_add_u32 v162, 1, v162
    s_cmp_lg_u32 s50, 8
    s_cbranch_scc1 C_G_TT_NOW
    s_waitcnt vmcnt(0)
C_G_TT_NOW:
    s_waitcnt lgkmcnt(0)
    s_barrier
    ds_read_b128 v[72:75], v8
    ds_read_b64_tr_b16 v[88:89], v12 offset:0
    ds_read_b64_tr_b16 v[90:91], v12 offset:768
    ds_read_b64_tr_b16 v[92:93], v12 offset:56
    ds_read_b64_tr_b16 v[94:95], v12 offset:824
    ds_read_b128 v[76:79], v9
    ds_read_b64_tr_b16 v[96:97], v12 offset:3072
    ds_read_b64_tr_b16 v[98:99], v12 offset:3840
    ds_read_b64_tr_b16 v[100:101], v12 offset:3128
    ds_read_b64_tr_b16 v[102:103], v12 offset:3896
    ds_read_b128 v[80:83], v10
    ds_read_b64_tr_b16 v[104:105], v12 offset:6144
    ds_read_b64_tr_b16 v[106:107], v12 offset:6912
    ds_read_b64_tr_b16 v[108:109], v12 offset:6200
    ds_read_b64_tr_b16 v[110:111], v12 offset:6968
    ds_read_b128 v[84:87], v11
    ds_read_b64_tr_b16 v[112:113], v12 offset:9216
    ds_read_b64_tr_b16 v[114:115], v12 offset:9984
    ds_read_b64_tr_b16 v[116:117], v12 offset:9272
    ds_read_b64_tr_b16 v[118:119], v12 offset:10040
    v_mfma_f32_32x32x16_bf16 v[120:135], v[40:43], v[24:27], v[120:135]
    v_mfma_f32_32x32x16_bf16 v[136:151], v[44:47], v[24:27], v[136:151]
    v_mfma_f32_32x32x16_bf16 v[120:135], v[48:51], v[28:31], v[120:135]
    v_mfma_f32_32x32x16_bf16 v[136:151], v[52:55], v[28:31], v[136:151]
    v_mfma_f32_32x32x16_bf16 v[120:135], v[56:59], v[32:35], v[120:135]
    v_mfma_f32_32x32x16_bf16 v[136:151], v[60:63], v[32:35], v[136:151]
    v_mfma_f32_32x32x16_bf16 v[120:135], v[64:67], v[36:39], v[120:135]
    v_mfma_f32_32x32x16_bf16 v[136:151], v[68:71], v[36:39], v[136:151]
    v_add_u32 v8, s61, v2
    v_add_u32 v9, s61, v3
    v_add_u32 v10, s61, v4
    v_add_u32 v11, s61, v5
    v_add_u32 v12, s61, v6
    s_add_u32 s61, s61, 28672
    s_cmp_eq_u32 s61, 143360
    s_cselect_b32 s61, 0, s61
    v_add_u32 v162, 1, v162
    s_cmp_eq_u32 s50, 6
    s_cbranch_scc1 C_G_TT_EPI
C_G_TT_BACK:
    s_waitcnt lgkmcnt(0)
    s_add_u32 s50, s50, 2
    s_cmp_lt_u32 s50, 14
    s_cbranch_scc1 C_G_TT_LOOP
    v_mfma_f32_32x32x16_bf16 v[120:135], v[88:91], v[72:75], v[120:135]
    v_mfma_f32_32x32x16_bf16 v[136:151], v[92:95], v[72:75], v[136:151]
    v_mfma_f32_32x32x16_bf16 v[120:135], v[96:99], v[76:79], v[120:135]
    v_mfma_f32_32x32x16_bf16 v[136:151], v[100:103], v[76:79], v[136:151]
    v_mfma_f32_32x32x16_bf16 v[120:135], v[104:107], v[80:83], v[120:135]
    v_mfma_f32_32x32x16_bf16 v[136:151], v[108:111], v[80:83], v[136:151]
    v_mfma_f32_32x32x16_bf16 v[120:135], v[112:115], v[84:87], v[120:135]
    v_mfma_f32_32x32x16_bf16 v[136:151], v[116:119], v[84:87], v[136:151]
C_G_TT_EPI:
    s_nop 15
    s_add_u32 s56, s54, 0
    s_lshr_b32 s57, s56, 4
    s_and_b32 s56, s56, 15
    s_lshl_b32 s56, s56, 6
    s_add_u32 s56, s56, s51
    s_lshl_b32 s58, s56, 11
    s_add_u32 s58, s58, s52
    s_lshl_b32 s59, s56, 12
    s_add_u32 s59, s59, s53
    s_mov_b32 s60, 0x3e8b97f6
    s_cmp_eq_u32 s57, 0
    s_cselect_b32 s58, s58, s59
    s_cselect_b32 s60, s60, 1.0
    v_mul_f32 v120, s60, v120
    v_mul_f32 v121, s60, v121
    v_mul_f32 v122, s60, v122
    v_mul_f32 v123, s60, v123
    v_mul_f32 v124, s60, v124
    v_mul_f32 v125, s60, v125
    v_mul_f32 v126, s60, v126
    v_mul_f32 v127, s60, v127
    v_mul_f32 v128, s60, v128
    v_mul_f32 v129, s60, v129
    v_mul_f32 v130, s60, v130
    v_mul_f32 v131, s60, v131
    v_mul_f32 v132, s60, v132
    v_mul_f32 v133, s60, v133
    v_mul_f32 v134, s60, v134
    v_mul_f32 v135, s60, v135
    v_cvt_pk_bf16_f32 v152, v120, v121
    v_cvt_pk_bf16_f32 v153, v122, v123
    v_cvt_pk_bf16_f32 v154, v124, v125
    v_cvt_pk_bf16_f32 v155, v126, v127
    v_cvt_pk_bf16_f32 v156, v128, v129
    v_cvt_pk_bf16_f32 v157, v130, v131
    v_cvt_pk_bf16_f32 v158, v132, v133
    v_cvt_pk_bf16_f32 v159, v134, v135
    s_mov_b32 exec_lo, 0
    v_mov_b32 v158, 0
    v_mov_b32 v159, 0
    s_mov_b32 exec_lo, -1
    buffer_store_dwordx4 v[152:155], v1, s[24:27], s58 offen sc1
    buffer_store_dwordx4 v[156:159], v1, s[24:27], s58 offen offset:1024 sc1
    s_nop 1
    s_add_u32 s56, s54, 1
    s_lshr_b32 s57, s56, 4
    s_and_b32 s56, s56, 15
    s_lshl_b32 s56, s56, 6
    s_add_u32 s56, s56, s51
    s_lshl_b32 s58, s56, 11
    s_add_u32 s58, s58, s52
    s_lshl_b32 s59, s56, 12
    s_add_u32 s59, s59, s53
    s_mov_b32 s60, 0x3e8b97f6
    s_cmp_eq_u32 s57, 0
    s_cselect_b32 s58, s58, s59
    s_cselect_b32 s60, s60, 1.0
    v_mul_f32 v136, s60, v136
    v_mul_f32 v137, s60, v137
    v_mul_f32 v138, s60, v138
    v_mul_f32 v139, s60, v139
    v_mul_f32 v140, s60, v140
    v_mul_f32 v141, s60, v141
    v_mul_f32 v142, s60, v142
    v_mul_f32 v143, s60, v143
    v_mul_f32 v144, s60, v144
    v_mul_f32 v145, s60, v145
    v_mul_f32 v146, s60, v146
    v_mul_f32 v147, s60, v147
    v_mul_f32 v148, s60, v148
    v_mul_f32 v149, s60, v149
    v_mul_f32 v150, s60, v150
    v_mul_f32 v151, s60, v151
    v_cvt_pk_bf16_f32 v152, v136, v137
    v_cvt_pk_bf16_f32 v153, v138, v139
    v_cvt_pk_bf16_f32 v154, v140, v141
    v_cvt_pk_bf16_f32 v155, v142, v143
    v_cvt_pk_bf16_f32 v156, v144, v145
    v_cvt_pk_bf16_f32 v157, v146, v147
    v_cvt_pk_bf16_f32 v158, v148, v149
    v_cvt_pk_bf16_f32 v159, v150, v151
    s_mov_b32 exec_lo, 0
    v_mov_b32 v158, 0
    v_mov_b32 v159, 0
    s_mov_b32 exec_lo, -1
    buffer_store_dwordx4 v[152:155], v1, s[24:27], s58 offen sc1
    buffer_store_dwordx4 v[156:159], v1, s[24:27], s58 offen offset:1024 sc1
    s_nop 1
    s_cmp_eq_u32 s50, 14
    s_cbranch_scc1 C_ATT
    v_mov_b32 v120, 0
    v_mov_b32 v121, 0
    v_mov_b32 v122, 0
    v_mov_b32 v123, 0
    v_mov_b32 v124, 0
    v_mov_b32 v125, 0
    v_mov_b32 v126, 0
    v_mov_b32 v127, 0
    v_mov_b32 v128, 0
    v_mov_b32 v129, 0
    v_mov_b32 v130, 0
    v_mov_b32 v131, 0
    v_mov_b32 v132, 0
    v_mov_b32 v133, 0
    v_mov_b32 v134, 0
    v_mov_b32 v135, 0
    v_mov_b32 v136, 0
    v_mov_b32 v137, 0
    v_mov_b32 v138, 0
    v_mov_b32 v139, 0
    v_mov_b32 v140, 0
    v_mov_b32 v141, 0
    v_mov_b32 v142, 0
    v_mov_b32 v143, 0
    v_mov_b32 v144, 0
    v_mov_b32 v145, 0
    v_mov_b32 v146, 0
    v_mov_b32 v147, 0
    v_mov_b32 v148, 0
    v_mov_b32 v149, 0
    v_mov_b32 v150, 0
    v_mov_b32 v151, 0
    s_and_b32 s3, s48, 1
    s_lshl_b32 s3, s3, 5
    s_lshl_b32 s51, s41, 1
    s_add_u32 s51, s51, s3
    s_lshr_b32 s3, s48, 1
    s_add_u32 s51, s51, s3
    s_mov_b32 s52, 0x600000
    s_mov_b32 s53, 0x800000
    s_add_u32 s42, s42, 2
    s_and_b32 s42, s42, 15
    s_mul_i32 s54, s42, 3
    s_lshl_b32 s3, s49, 1
    s_add_u32 s54, s54, s3
    s_cmp_le_u32 s42, 10
    s_cbranch_scc1 C_G_TT_BACK
    s_branch C_G_NN_BACK
C_G_NN_LOOP:
    s_barrier
    ds_read_b128 v[24:27], v8
    ds_read_b64_tr_b16 v[40:41], v12 offset:0
    ds_read_b64_tr_b16 v[42:43], v12 offset:768
    ds_read_b64_tr_b16 v[44:45], v12 offset:56
    ds_read_b64_tr_b16 v[46:47], v12 offset:824
    ds_read_b128 v[28:31], v9
    ds_read_b64_tr_b16 v[48:49], v12 offset:3072
    ds_read_b64_tr_b16 v[50:51], v12 offset:3840
    ds_read_b64_tr_b16 v[52:53], v12 offset:3128
    ds_read_b64_tr_b16 v[54:55], v12 offset:3896
    ds_read_b128 v[32:35], v10
    ds_read_b64_tr_b16 v[56:57], v12 offset:6144
    ds_read_b64_tr_b16 v[58:59], v12 offset:6912
    ds_read_b64_tr_b16 v[60:61], v12 offset:6200
    ds_read_b64_tr_b16 v[62:63], v12 offset:6968
    ds_read_b128 v[36:39], v11
    ds_read_b64_tr_b16 v[64:65], v12 offset:9216
    ds_read_b64_tr_b16 v[66:67], v12 offset:9984
    ds_read_b64_tr_b16 v[68:69], v12 offset:9272
    ds_read_b64_tr_b16 v[70:71], v12 offset:10040
    v_mfma_f32_32x32x16_bf16 v[120:135], v[72:75], v[88:91], v[120:135]
    v_mfma_f32_32x32x16_bf16 v[136:151], v[72:75], v[92:95], v[136:151]
    v_mfma_f32_32x32x16_bf16 v[120:135], v[76:79], v[96:99], v[120:135]
    v_mfma_f32_32x32x16_bf16 v[136:151], v[76:79], v[100:103], v[136:151]
    v_mfma_f32_32x32x16_bf16 v[120:135], v[80:83], v[104:107], v[120:135]
    v_mfma_f32_32x32x16_bf16 v[136:151], v[80:83], v[108:111], v[136:151]
    v_mfma_f32_32x32x16_bf16 v[120:135], v[84:87], v[112:115], v[120:135]
    v_mfma_f32_32x32x16_bf16 v[136:151], v[84:87], v[116:119], v[136:151]
    v_add_u32 v8, s61, v2
    v_add_u32 v9, s61, v3
    v_add_u32 v10, s61, v4
    v_add_u32 v11, s61, v5
    v_add_u32 v12, s61, v6
    s_add_u32 s61, s61, 28672
    s_cmp_eq_u32 s61, 143360
    s_cselect_b32 s61, 0, s61
    v_add_u32 v162, 1, v162
    s_cmp_lg_u32 s50, 8
    s_cbranch_scc1 C_G_NN_NOW
    s_waitcnt vmcnt(0)
C_G_NN_NOW:
    s_waitcnt lgkmcnt(0)
    s_barrier
    ds_read_b128 v[72:75], v8
    ds_read_b64_tr_b16 v[88:89], v12 offset:0
    ds_read_b64_tr_b16 v[90:91], v12 offset:768
    ds_read_b64_tr_b16 v[92:93], v12 offset:56
    ds_read_b64_tr_b16 v[94:95], v12 offset:824
    ds_read_b128 v[76:79], v9
    ds_read_b64_tr_b16 v[96:97], v12 offset:3072
    ds_read_b64_tr_b16 v[98:99], v12 offset:3840
    ds_read_b64_tr_b16 v[100:101], v12 offset:3128
    ds_read_b64_tr_b16 v[102:103], v12 offset:3896
    ds_read_b128 v[80:83], v10
    ds_read_b64_tr_b16 v[104:105], v12 offset:6144
    ds_read_b64_tr_b16 v[106:107], v12 offset:6912
    ds_read_b64_tr_b16 v[108:109], v12 offset:6200
    ds_read_b64_tr_b16 v[110:111], v12 offset:6968
    ds_read_b128 v[84:87], v11
    ds_read_b64_tr_b16 v[112:113], v12 offset:9216
    ds_read_b64_tr_b16 v[114:115], v12 offset:9984
    ds_read_b64_tr_b16 v[116:117], v12 offset:9272
    ds_read_b64_tr_b16 v[118:119], v12 offset:10040
    v_mfma_f32_32x32x16_bf16 v[120:135], v[24:27], v[40:43], v[120:135]
    v_mfma_f32_32x32x16_bf16 v[136:151], v[24:27], v[44:47], v[136:151]
    v_mfma_f32_32x32x16_bf16 v[120:135], v[28:31], v[48:51], v[120:135]
    v_mfma_f32_32x32x16_bf16 v[136:151], v[28:31], v[52:55], v[136:151]
    v_mfma_f32_32x32x16_bf16 v[120:135], v[32:35], v[56:59], v[120:135]
    v_mfma_f32_32x32x16_bf16 v[136:151], v[32:35], v[60:63], v[136:151]
    v_mfma_f32_32x32x16_bf16 v[120:135], v[36:39], v[64:67], v[120:135]
    v_mfma_f32_32x32x16_bf16 v[136:151], v[36:39], v[68:71], v[136:151]
    v_add_u32 v8, s61, v2
    v_add_u32 v9, s61, v3
    v_add_u32 v10, s61, v4
    v_add_u32 v11, s61, v5
    v_add_u32 v12, s61, v6
    s_add_u32 s61, s61, 28672
    s_cmp_eq_u32 s61, 143360
    s_cselect_b32 s61, 0, s61
    v_add_u32 v162, 1, v162
    s_cmp_eq_u32 s50, 6
    s_cbranch_scc1 C_G_NN_EPI
C_G_NN_BACK:
    s_waitcnt lgkmcnt(0)
    s_add_u32 s50, s50, 2
    s_cmp_lt_u32 s50, 14
    s_cbranch_scc1 C_G_NN_LOOP
    v_mfma_f32_32x32x16_bf16 v[120:135], v[72:75], v[88:91], v[120:135]
    v_mfma_f32_32x32x16_bf16 v[136:151], v[72:75], v[92:95], v[136:151]
    v_mfma_f32_32x32x16_bf16 v[120:135], v[76:79], v[96:99], v[120:135]
    v_mfma_f32_32x32x16_bf16 v[136:151], v[76:79], v[100:103], v[136:151]
    v_mfma_f32_32x32x16_bf16 v[120:135], v[80:83], v[104:107], v[120:135]
    v_mfma_f32_32x32x16_bf16 v[136:151], v[80:83], v[108:111], v[136:151]
    v_mfma_f32_32x32x16_bf16 v[120:135], v[84:87], v[112:115], v[120:135]
    v_mfma_f32_32x32x16_bf16 v[136:151], v[84:87], v[116:119], v[136:151]
C_G_NN_EPI:
    s_nop 15
    s_add_u32 s56, s54, 0
    s_lshr_b32 s57, s56, 4
    s_and_b32 s56, s56, 15
    s_lshl_b32 s56, s56, 6
    s_add_u32 s56, s56, s51
    s_lshl_b32 s58, s56, 12
    s_add_u32 s58, s58, s53
    s_add_u32 s58, s58, 2048
    v_cvt_pk_bf16_f32 v152, v120, v121
    v_cvt_pk_bf16_f32 v153, v122, v123
    v_cvt_pk_bf16_f32 v154, v124, v125
    v_cvt_pk_bf16_f32 v155, v126, v127
    v_cvt_pk_bf16_f32 v156, v128, v129
    v_cvt_pk_bf16_f32 v157, v130, v131
    v_cvt_pk_bf16_f32 v158, v132, v133
    v_cvt_pk_bf16_f32 v159, v134, v135
    s_mov_b32 exec_lo, 0xe0000000
    s_mov_b32 exec_hi, 0xe0000000
    v_mov_b32 v152, 0
    v_mov_b32 v153, 0
    v_mov_b32 v154, 0
    v_mov_b32 v155, 0
    v_mov_b32 v156, 0
    v_mov_b32 v157, 0
    v_mov_b32 v158, 0
    v_mov_b32 v159, 0
    s_mov_b32 exec_lo, 0x10000000
    s_mov_b32 exec_hi, 0x10000000
    v_mov_b32 v152, 0x3f803f80
    v_mov_b32 v153, 0x3f803f80
    v_mov_b32 v154, 0x3f803f80
    v_mov_b32 v155, 0x3f803f80
    v_mov_b32 v156, 0x3f803f80
    v_mov_b32 v157, 0x3f803f80
    v_mov_b32 v158, 0x3f803f80
    v_mov_b32 v159, 0x3f803f80
    s_mov_b64 exec, -1
    buffer_store_dwordx4 v[152:155], v1, s[24:27], s58 offen sc1
    buffer_store_dwordx4 v[156:159], v1, s[24:27], s58 offen offset:1024 sc1
    s_nop 1
    s_add_u32 s56, s54, 1
    s_lshr_b32 s57, s56, 4
    s_and_b32 s56, s56, 15
    s_lshl_b32 s56, s56, 6
    s_add_u32 s56, s56, s51
    s_lshl_b32 s58, s56, 12
    s_add_u32 s58, s58, s53
    s_add_u32 s58, s58, 2048
    v_cvt_pk_bf16_f32 v152, v136, v137
    v_cvt_pk_bf16_f32 v153, v138, v139
    v_cvt_pk_bf16_f32 v154, v140, v141
    v_cvt_pk_bf16_f32 v155, v142, v143
    v_cvt_pk_bf16_f32 v156, v144, v145
    v_cvt_pk_bf16_f32 v157, v146, v147
    v_cvt_pk_bf16_f32 v158, v148, v149
    v_cvt_pk_bf16_f32 v159, v150, v151
    s_mov_b32 exec_lo, 0xe0000000
    s_mov_b32 exec_hi, 0xe0000000
    v_mov_b32 v152, 0
    v_mov_b32 v153, 0
    v_mov_b32 v154, 0
    v_mov_b32 v155, 0
    v_mov_b32 v156, 0
    v_mov_b32 v157, 0
    v_mov_b32 v158, 0
    v_mov_b32 v159, 0
    s_mov_b32 exec_lo, 0x10000000
    s_mov_b32 exec_hi, 0x10000000
    v_mov_b32 v152, 0x3f803f80
    v_mov_b32 v153, 0x3f803f80
    v_mov_b32 v154, 0x3f803f80
    v_mov_b32 v155, 0x3f803f80
    v_mov_b32 v156, 0x3f803f80
    v_mov_b32 v157, 0x3f803f80
    v_mov_b32 v158, 0x3f803f80
    v_mov_b32 v159, 0x3f803f80
    s_mov_b64 exec, -1
    buffer_store_dwordx4 v[152:155], v1, s[24:27], s58 offen sc1
    buffer_store_dwordx4 v[156:159], v1, s[24:27], s58 offen offset:1024 sc1
    s_nop 1
    s_cmp_eq_u32 s50, 14
    s_cbranch_scc1 C_ATT
    v_mov_b32 v120, 0
    v_mov_b32 v121, 0
    v_mov_b32 v122, 0
    v_mov_b32 v123, 0
    v_mov_b32 v124, 0
    v_mov_b32 v125, 0
    v_mov_b32 v126, 0
    v_mov_b32 v127, 0
    v_mov_b32 v128, 0
    v_mov_b32 v129, 0
    v_mov_b32 v130, 0
    v_mov_b32 v131, 0
    v_mov_b32 v132, 0
    v_mov_b32 v133, 0
    v_mov_b32 v134, 0
    v_mov_b32 v135, 0
    v_mov_b32 v136, 0
    v_mov_b32 v137, 0
    v_mov_b32 v138, 0
    v_mov_b32 v139, 0
    v_mov_b32 v140, 0
    v_mov_b32 v141, 0
    v_mov_b32 v142, 0
    v_mov_b32 v143, 0
    v_mov_b32 v144, 0
    v_mov_b32 v145, 0
    v_mov_b32 v146, 0
    v_mov_b32 v147, 0
    v_mov_b32 v148, 0
    v_mov_b32 v149, 0
    v_mov_b32 v150, 0
    v_mov_b32 v151, 0
    s_and_b32 s3, s48, 1
    s_lshl_b32 s3, s3, 5
    s_lshl_b32 s51, s41, 1
    s_add_u32 s51, s51, s3
    s_lshr_b32 s3, s48, 1
    s_add_u32 s51, s51, s3
    s_mov_b32 s52, 0x600000
    s_mov_b32 s53, 0x800000
    s_add_u32 s42, s42, 2
    s_and_b32 s42, s42, 15
    s_mul_i32 s54, s42, 3
    s_lshl_b32 s3, s49, 1
    s_add_u32 s54, s54, s3
    s_cmp_le_u32 s42, 10
    s_cbranch_scc1 C_G_TT_BACK
    s_branch C_G_NN_BACK
C_G_T_LOOP:
    s_barrier
    ds_read_b128 v[24:27], v8
    ds_read_b64_tr_b16 v[40:41], v12 offset:0
    ds_read_b64_tr_b16 v[42:43], v12 offset:768
    ds_read_b128 v[28:31], v9
    ds_read_b64_tr_b16 v[48:49], v12 offset:3072
    ds_read_b64_tr_b16 v[50:51], v12 offset:3840
    ds_read_b128 v[32:35], v10
    ds_read_b64_tr_b16 v[56:57], v12 offset:6144
    ds_read_b64_tr_b16 v[58:59], v12 offset:6912
    ds_read_b128 v[36:39], v11
    ds_read_b64_tr_b16 v[64:65], v12 offset:9216
    ds_read_b64_tr_b16 v[66:67], v12 offset:9984
    v_mfma_f32_32x32x16_bf16 v[120:135], v[88:91], v[72:75], v[120:135]
    v_mfma_f32_32x32x16_bf16 v[120:135], v[96:99], v[76:79], v[120:135]
    v_mfma_f32_32x32x16_bf16 v[120:135], v[104:107], v[80:83], v[120:135]
    v_mfma_f32_32x32x16_bf16 v[120:135], v[112:115], v[84:87], v[120:135]
    v_add_u32 v8, s61, v2
    v_add_u32 v9, s61, v3
    v_add_u32 v10, s61, v4
    v_add_u32 v11, s61, v5
    v_add_u32 v12, s61, v6
    s_add_u32 s61, s61, 28672
    s_cmp_eq_u32 s61, 143360
    s_cselect_b32 s61, 0, s61
    v_add_u32 v162, 1, v162
    s_cmp_lg_u32 s50, 8
    s_cbranch_scc1 C_G_T_NOW
    s_waitcnt vmcnt(0)
C_G_T_NOW:
    s_waitcnt lgkmcnt(0)
    s_barrier
    ds_read_b128 v[72:75], v8
    ds_read_b64_tr_b16 v[88:89], v12 offset:0
    ds_read_b64_tr_b16 v[90:91], v12 offset:768
    ds_read_b128 v[76:79], v9
    ds_read_b64_tr_b16 v[96:97], v12 offset:3072
    ds_read_b64_tr_b16 v[98:99], v12 offset:3840
    ds_read_b128 v[80:83], v10
    ds_read_b64_tr_b16 v[104:105], v12 offset:6144
    ds_read_b64_tr_b16 v[106:107], v12 offset:6912
    ds_read_b128 v[84:87], v11
    ds_read_b64_tr_b16 v[112:113], v12 offset:9216
    ds_read_b64_tr_b16 v[114:115], v12 offset:9984
    v_mfma_f32_32x32x16_bf16 v[120:135], v[40:43], v[24:27], v[120:135]
    v_mfma_f32_32x32x16_bf16 v[120:135], v[48:51], v[28:31], v[120:135]
    v_mfma_f32_32x32x16_bf16 v[120:135], v[56:59], v[32:35], v[120:135]
    v_mfma_f32_32x32x16_bf16 v[120:135], v[64:67], v[36:39], v[120:135]
    v_add_u32 v8, s61, v2
    v_add_u32 v9, s61, v3
    v_add_u32 v10, s61, v4
    v_add_u32 v11, s61, v5
    v_add_u32 v12, s61, v6
    s_add_u32 s61, s61, 28672
    s_cmp_eq_u32 s61, 143360
    s_cselect_b32 s61, 0, s61
    v_add_u32 v162, 1, v162
    s_cmp_eq_u32 s50, 6
    s_cbranch_scc1 C_G_T_EPI
C_G_T_BACK:
    s_waitcnt lgkmcnt(0)
    s_add_u32 s50, s50, 2
    s_cmp_lt_u32 s50, 14
    s_cbranch_scc1 C_G_T_LOOP
    v_mfma_f32_32x32x16_bf16 v[120:135], v[88:91], v[72:75], v[120:135]
    v_mfma_f32_32x32x16_bf16 v[120:135], v[96:99], v[76:79], v[120:135]
    v_mfma_f32_32x32x16_bf16 v[120:135], v[104:107], v[80:83], v[120:135]
    v_mfma_f32_32x32x16_bf16 v[120:135], v[112:115], v[84:87], v[120:135]
C_G_T_EPI:
    s_nop 15
    s_add_u32 s56, s54, 0
    s_lshr_b32 s57, s56, 4
    s_and_b32 s56, s56, 15
    s_lshl_b32 s56, s56, 6
    s_add_u32 s56, s56, s51
    s_lshl_b32 s58, s56, 11
    s_add_u32 s58, s58, s52
    s_lshl_b32 s59, s56, 12
    s_add_u32 s59, s59, s53
    s_mov_b32 s60, 0x3e8b97f6
    s_cmp_eq_u32 s57, 0
    s_cselect_b32 s58, s58, s59
    s_cselect_b32 s60, s60, 1.0
    v_mul_f32 v120, s60, v120
    v_mul_f32 v121, s60, v121
    v_mul_f32 v122, s60, v122
    v_mul_f32 v123, s60, v123
    v_mul_f32 v124, s60, v124
    v_mul_f32 v125, s60, v125
    v_mul_f32 v126, s60, v126
    v_mul_f32 v127, s60, v127
    v_mul_f32 v128, s60, v128
    v_mul_f32 v129, s60, v129
    v_mul_f32 v130, s60, v130
    v_mul_f32 v131, s60, v131
    v_mul_f32 v132, s60, v132
    v_mul_f32 v133, s60, v133
    v_mul_f32 v134, s60, v134
    v_mul_f32 v135, s60, v135
    v_cvt_pk_bf16_f32 v152, v120, v121
    v_cvt_pk_bf16_f32 v153, v122, v123
    v_cvt_pk_bf16_f32 v154, v124, v125
    v_cvt_pk_bf16_f32 v155, v126, v127
    v_cvt_pk_bf16_f32 v156, v128, v129
    v_cvt_pk_bf16_f32 v157, v130, v131
    v_cvt_pk_bf16_f32 v158, v132, v133
    v_cvt_pk_bf16_f32 v159, v134, v135
    s_mov_b32 exec_lo, 0
    v_mov_b32 v158, 0
    v_mov_b32 v159, 0
    s_mov_b32 exec_lo, -1
    buffer_store_dwordx4 v[152:155], v1, s[24:27], s58 offen sc1
    buffer_store_dwordx4 v[156:159], v1, s[24:27], s58 offen offset:1024 sc1
    s_nop 1
    s_cmp_eq_u32 s50, 14
    s_cbranch_scc1 C_ATT
    v_mov_b32 v120, 0
    v_mov_b32 v121, 0
    v_mov_b32 v122, 0
    v_mov_b32 v123, 0
    v_mov_b32 v124, 0
    v_mov_b32 v125, 0
    v_mov_b32 v126, 0
    v_mov_b32 v127, 0
    v_mov_b32 v128, 0
    v_mov_b32 v129, 0
    v_mov_b32 v130, 0
    v_mov_b32 v131, 0
    v_mov_b32 v132, 0
    v_mov_b32 v133, 0
    v_mov_b32 v134, 0
    v_mov_b32 v135, 0
    s_and_b32 s3, s48, 1
    s_lshl_b32 s3, s3, 5
    s_lshl_b32 s51, s41, 1
    s_add_u32 s51, s51, s3
    s_lshr_b32 s3, s48, 1
    s_add_u32 s51, s51, s3
    s_mov_b32 s52, 0x600000
    s_mov_b32 s53, 0x800000
    s_add_u32 s42, s42, 2
    s_and_b32 s42, s42, 15
    s_mul_i32 s54, s42, 3
    s_lshl_b32 s3, s49, 1
    s_add_u32 s54, s54, s3
    s_cmp_le_u32 s42, 9
    s_cbranch_scc1 C_G_T_BACK
    s_branch C_G_N_BACK
C_G_N_LOOP:
    s_barrier
    ds_read_b128 v[24:27], v8
    ds_read_b64_tr_b16 v[40:41], v12 offset:0
    ds_read_b64_tr_b16 v[42:43], v12 offset:768
    ds_read_b128 v[28:31], v9
    ds_read_b64_tr_b16 v[48:49], v12 offset:3072
    ds_read_b64_tr_b16 v[50:51], v12 offset:3840
    ds_read_b128 v[32:35], v10
    ds_read_b64_tr_b16 v[56:57], v12 offset:6144
    ds_read_b64_tr_b16 v[58:59], v12 offset:6912
    ds_read_b128 v[36:39], v11
    ds_read_b64_tr_b16 v[64:65], v12 offset:9216
    ds_read_b64_tr_b16 v[66:67], v12 offset:9984
    v_mfma_f32_32x32x16_bf16 v[120:135], v[72:75], v[88:91], v[120:135]
    v_mfma_f32_32x32x16_bf16 v[120:135], v[76:79], v[96:99], v[120:135]
    v_mfma_f32_32x32x16_bf16 v[120:135], v[80:83], v[104:107], v[120:135]
    v_mfma_f32_32x32x16_bf16 v[120:135], v[84:87], v[112:115], v[120:135]
    v_add_u32 v8, s61, v2
    v_add_u32 v9, s61, v3
    v_add_u32 v10, s61, v4
    v_add_u32 v11, s61, v5
    v_add_u32 v12, s61, v6
    s_add_u32 s61, s61, 28672
    s_cmp_eq_u32 s61, 143360
    s_cselect_b32 s61, 0, s61
    v_add_u32 v162, 1, v162
    s_cmp_lg_u32 s50, 8
    s_cbranch_scc1 C_G_N_NOW
    s_waitcnt vmcnt(0)
C_G_N_NOW:
    s_waitcnt lgkmcnt(0)
    s_barrier
    ds_read_b128 v[72:75], v8
    ds_read_b64_tr_b16 v[88:89], v12 offset:0
    ds_read_b64_tr_b16 v[90:91], v12 offset:768
    ds_read_b128 v[76:79], v9
    ds_read_b64_tr_b16 v[96:97], v12 offset:3072
    ds_read_b64_tr_b16 v[98:99], v12 offset:3840
    ds_read_b128 v[80:83], v10
    ds_read_b64_tr_b16 v[104:105], v12 offset:6144
    ds_read_b64_tr_b16 v[106:107], v12 offset:6912
    ds_read_b128 v[84:87], v11
    ds_read_b64_tr_b16 v[112:113], v12 offset:9216
    ds_read_b64_tr_b16 v[114:115], v12 offset:9984
    v_mfma_f32_32x32x16_bf16 v[120:135], v[24:27], v[40:43], v[120:135]
    v_mfma_f32_32x32x16_bf16 v[120:135], v[28:31], v[48:51], v[120:135]
    v_mfma_f32_32x32x16_bf16 v[120:135], v[32:35], v[56:59], v[120:135]
    v_mfma_f32_32x32x16_bf16 v[120:135], v[36:39], v[64:67], v[120:135]
    v_add_u32 v8, s61, v2
    v_add_u32 v9, s61, v3
    v_add_u32 v10, s61, v4
    v_add_u32 v11, s61, v5
    v_add_u32 v12, s61, v6
    s_add_u32 s61, s61, 28672
    s_cmp_eq_u32 s61, 143360
    s_cselect_b32 s61, 0, s61
    v_add_u32 v162, 1, v162
    s_cmp_eq_u32 s50, 6
    s_cbranch_scc1 C_G_N_EPI
C_G_N_BACK:
    s_waitcnt lgkmcnt(0)
    s_add_u32 s50, s50, 2
    s_cmp_lt_u32 s50, 14
    s_cbranch_scc1 C_G_N_LOOP
    v_mfma_f32_32x32x16_bf16 v[120:135], v[72:75], v[88:91], v[120:135]
    v_mfma_f32_32x32x16_bf16 v[120:135], v[76:79], v[96:99], v[120:135]
    v_mfma_f32_32x32x16_bf16 v[120:135], v[80:83], v[104:107], v[120:135]
    v_mfma_f32_32x32x16_bf16 v[120:135], v[84:87], v[112:115], v[120:135]
C_G_N_EPI:
    s_nop 15
    s_add_u32 s56, s54, 0
    s_lshr_b32 s57, s56, 4
    s_and_b32 s56, s56, 15
    s_lshl_b32 s56, s56, 6
    s_add_u32 s56, s56, s51
    s_lshl_b32 s58, s56, 12
    s_add_u32 s58, s58, s53
    s_add_u32 s58, s58, 2048
    v_cvt_pk_bf16_f32 v152, v120, v121
    v_cvt_pk_bf16_f32 v153, v122, v123
    v_cvt_pk_bf16_f32 v154, v124, v125
    v_cvt_pk_bf16_f32 v155, v126, v127
    v_cvt_pk_bf16_f32 v156, v128, v129
    v_cvt_pk_bf16_f32 v157, v130, v131
    v_cvt_pk_bf16_f32 v158, v132, v133
    v_cvt_pk_bf16_f32 v159, v134, v135
    s_mov_b32 exec_lo, 0xe0000000
    s_mov_b32 exec_hi, 0xe0000000
    v_mov_b32 v152, 0
    v_mov_b32 v153, 0
    v_mov_b32 v154, 0
    v_mov_b32 v155, 0
    v_mov_b32 v156, 0
    v_mov_b32 v157, 0
    v_mov_b32 v158, 0
    v_mov_b32 v159, 0
    s_mov_b32 exec_lo, 0x10000000
    s_mov_b32 exec_hi, 0x10000000
    v_mov_b32 v152, 0x3f803f80
    v_mov_b32 v153, 0x3f803f80
    v_mov_b32 v154, 0x3f803f80
    v_mov_b32 v155, 0x3f803f80
    v_mov_b32 v156, 0x3f803f80
    v_mov_b32 v157, 0x3f803f80
    v_mov_b32 v158, 0x3f803f80
    v_mov_b32 v159, 0x3f803f80
    s_mov_b64 exec, -1
    buffer_store_dwordx4 v[152:155], v1, s[24:27], s58 offen sc1
    buffer_store_dwordx4 v[156:159], v1, s[24:27], s58 offen offset:1024 sc1
    s_nop 1
    s_cmp_eq_u32 s50, 14
    s_cbranch_scc1 C_ATT
    v_mov_b32 v120, 0
    v_mov_b32 v121, 0
    v_mov_b32 v122, 0
    v_mov_b32 v123, 0
    v_mov_b32 v124, 0
    v_mov_b32 v125, 0
    v_mov_b32 v126, 0
    v_mov_b32 v127, 0
    v_mov_b32 v128, 0
    v_mov_b32 v129, 0
    v_mov_b32 v130, 0
    v_mov_b32 v131, 0
    v_mov_b32 v132, 0
    v_mov_b32 v133, 0
    v_mov_b32 v134, 0
    v_mov_b32 v135, 0
    s_and_b32 s3, s48, 1
    s_lshl_b32 s3, s3, 5
    s_lshl_b32 s51, s41, 1
    s_add_u32 s51, s51, s3
    s_lshr_b32 s3, s48, 1
    s_add_u32 s51, s51, s3
    s_mov_b32 s52, 0x600000
    s_mov_b32 s53, 0x800000
    s_add_u32 s42, s42, 2
    s_and_b32 s42, s42, 15
    s_mul_i32 s54, s42, 3
    s_lshl_b32 s3, s49, 1
    s_add_u32 s54, s54, s3
    s_cmp_le_u32 s42, 9
    s_cbranch_scc1 C_G_T_BACK
    s_branch C_G_N_BACK
C_ATT:
    s_lshl_b32 s51, s44, 2
    s_add_u32 s51, s51, s48
    s_lshl_b32 s3, s48, 11
    s_add_u32 s3, s3, 143360
    v_add_u32 v46, s3, v1
    s_lshl_b32 s3, s49, 14
    s_add_u32 s3, s3, 65536
    v_add_u32 v2, s3, v1
    v_add_u32 v3, 32768, v2
    v_add_u32 v47, 65536, v1
    v_mov_b32 v48, 0
    v_mov_b32 v49, 0
    v_mov_b32 v50, 0
    v_mov_b32 v51, 0
    v_mov_b32 v52, 0
    v_mov_b32 v53, 0
    v_mov_b32 v54, 0
    v_mov_b32 v55, 0
    v_mov_b32 v56, 0
    v_mov_b32 v57, 0
    v_mov_b32 v58, 0
    v_mov_b32 v59, 0
    v_mov_b32 v60, 0
    v_mov_b32 v61, 0
    v_mov_b32 v62, 0
    v_mov_b32 v63, 0
    v_mov_b32 v40, 0
    v_mov_b32 v24, 0
    v_mov_b32 v41, 0
    v_mov_b32 v25, 0
    v_mov_b32 v42, 0
    v_mov_b32 v26, 0
    v_mov_b32 v43, 0
    v_mov_b32 v27, 0
    s_and_b32 s52, s40, 1
    s_bfe_u32 s53, s40, 0x10001
    s_lshl_b32 s3, s48, 12
    s_add_u32 s3, s3, 32768
    v_add_u32 v152, s3, v1
    s_lshl_b32 s3, s48, 8
    s_add_u32 s3, s3, 49152
    v_lshlrev_b32 v153, 2, v0
    v_add_u32 v153, s3, v153
    v_lshrrev_b32 v6, 5, v0
    v_bfe_u32 v7, v0, 2, 2
    v_lshl_add_u32 v6, v6, 2, v7
    v_lshlrev_b32 v6, 7, v6
    v_bfe_u32 v7, v0, 4, 1
    v_lshl_add_u32 v6, v7, 5, v6
    v_and_b32 v7, 3, v0
    v_lshl_add_u32 v6, v7, 3, v6
    v_bfe_u32 v7, v0, 3, 1
    v_lshl_add_u32 v156, v7, 6, v6
    s_mul_i32 s3, s53, 28672
    s_add_u32 s3, s3, 65536
    s_mul_i32 s60, s53, 131072
    s_cmp_eq_u32 s49, 1
    s_cselect_b32 s3, s3, s60
    v_add_u32 v156, s3, v156
    v_xor_b32 v157, 64, v156
    s_lshl_b32 s3, s40, 12
    s_add_u32 s3, s3, 32768
    v_add_u32 v160, s3, v1
    s_xor_b32 s3, s40, 2
    s_lshl_b32 s3, s3, 12
    s_add_u32 s3, s3, 32768
    v_add_u32 v159, s3, v1
    s_mov_b32 s36, s16
    s_and_b32 s37, s17, 0xffff
    s_mov_b32 s38, 0x380000
    s_mov_b32 s39, 0x20000
    v_and_b32 v11, 31, v0
    s_xor_b32 s3, s49, 1
    v_lshlrev_b32 v11, s3, v11
    s_mul_i32 s3, s49, 5
    s_lshl_b32 s3, s52, s3
    s_lshl_b32 s60, s45, 6
    s_add_u32 s3, s3, s60
    v_add_u32 v158, s3, v11
    v_mul_u32_u24 v158, 1792, v158
    v_lshrrev_b32 v11, 5, v0
    v_lshl_add_u32 v158, v11, 4, v158
    s_lshl_b32 s60, s46, 7
    s_lshl_b32 s3, s53, 6
    s_add_u32 s60, s60, s3
    s_mul_i32 s3, s49, 896
    s_add_u32 s60, s60, s3
    s_lshl_b32 s3, s45, 1
    s_add_u32 s3, s3, s52
    s_lshl_b32 s59, s3, 15
    s_add_u32 s59, s59, 0xe00000
    s_lshl_b32 s3, s3, 3
    s_add_u32 s3, s3, s46
    s_lshl_b32 s3, s3, 7
    s_lshl_b32 s56, s53, 6
    s_add_u32 s3, s3, s56
    s_add_u32 s3, s3, 0x1010000
    v_lshlrev_b32 v161, 2, v0
    v_add_u32 v161, s3, v161
    s_lshl_b32 s58, s52, 5
    s_add_u32 s58, s58, s45
    s_lshl_b32 s58, s58, 15
    s_add_u32 s58, s58, 0xc00000
    s_cmp_eq_u32 s49, 1
    s_cselect_b32 s58, s59, s58
    s_lshl_b32 s3, s53, 14
    s_add_u32 s58, s58, s3
    s_add_u32 s59, s58, 4096
    s_add_u32 s61, s58, 8192
    s_add_u32 s63, s58, 12288
    s_lshl_b32 s57, s51, 4
    s_add_u32 s57, s57, s43
    s_lshl_b32 s57, s57, 1
    s_add_u32 s57, s57, s49
    s_and_b32 s56, s57, 31
    s_lshl_b32 s56, s56, 2
    s_lshl_b32 s3, s51, 10
    s_add_u32 s56, s56, s3
    s_add_u32 s56, s56, 0x1010000
    v_lshlrev_b32 v154, 7, v0
    s_lshl_b32 s57, s57, 10
    s_add_u32 s57, s57, 0xe00000
    s_barrier
    ds_read_b128 v[4:7], v46
    ds_read_b128 v[8:11], v46 offset:1024
    ds_read_b128 v[12:15], v47
    ds_read_b128 v[16:19], v47 offset:1024
    s_waitcnt lgkmcnt(0)
    v_mfma_f32_32x32x16_bf16 v[96:111], v[12:15], v[4:7], 0
    v_mfma_f32_32x32x16_bf16 v[96:111], v[16:19], v[8:11], v[96:111]
    ds_read_b128 v[12:15], v2
    ds_read_b128 v[16:19], v2 offset:1024
    s_nop 15
    v_max3_f32 v44, v96, v97, v98
    v_max3_f32 v44, v44, v99, v100
    v_max3_f32 v44, v44, v101, v102
    v_max3_f32 v44, v44, v103, v104
    v_max3_f32 v44, v44, v105, v106
    v_max3_f32 v44, v44, v107, v108
    v_max3_f32 v44, v44, v109, v110
    v_max_f32 v44, v44, v111
    v_mov_b32 v45, v44
    s_nop 1
    v_permlane32_swap_b32 v44, v45
    s_nop 1
    v_max_f32 v44, v44, v45
    v_add_f32 v44, 0x42800000, v44
    v_sub_f32 v64, 0, v44
    v_sub_f32 v65, 0, v44
    v_sub_f32 v66, 0, v44
    v_sub_f32 v67, 0, v44
    v_sub_f32 v68, 0, v44
    v_sub_f32 v69, 0, v44
    v_sub_f32 v70, 0, v44
    v_sub_f32 v71, 0, v44
    v_sub_f32 v72, 0, v44
    v_sub_f32 v73, 0, v44
    v_sub_f32 v74, 0, v44
    v_sub_f32 v75, 0, v44
    v_sub_f32 v76, 0, v44
    v_sub_f32 v77, 0, v44
    v_sub_f32 v78, 0, v44
    v_sub_f32 v79, 0, v44
    s_waitcnt lgkmcnt(0)
    s_nop 0
    v_mfma_f32_32x32x16_bf16 v[80:95], v[12:15], v[4:7], v[64:79]
    v_mfma_f32_32x32x16_bf16 v[80:95], v[16:19], v[8:11], v[80:95]
    ds_read_b128 v[12:15], v2 offset:4096
    ds_read_b128 v[16:19], v2 offset:5120
    ds_read_b128 v[20:23], v2 offset:2048
    s_mov_b32 s54, 0
    s_nop 15
    s_cmp_ge_u32 s2, 224
    s_cselect_b32 s55, 9, 7
    s_cmp_eq_u32 s49, 1
    s_cselect_b32 s55, 9, s55
C_LOOP:
    s_setprio 1
    s_waitcnt lgkmcnt(1)
    v_mfma_f32_32x32x16_bf16 v[96:111], v[12:15], v[4:7], v[64:79]
    v_exp_f32 v80, v80
    v_exp_f32 v81, v81
    v_exp_f32 v82, v82
    v_exp_f32 v83, v83
    v_mfma_f32_32x32x16_bf16 v[96:111], v[16:19], v[8:11], v[96:111]
    ds_read_b128 v[12:15], v2 offset:8192
    ds_read_b128 v[16:19], v2 offset:9216
    v_exp_f32 v84, v84
    v_exp_f32 v85, v85
    v_exp_f32 v86, v86
    v_exp_f32 v87, v87
    v_cvt_pk_bf16_f32 v28, v80, v81
    v_cvt_pk_bf16_f32 v29, v82, v83
    v_mfma_f32_32x32x16_bf16 v[48:63], v[24:27], v[40:43], v[48:63]
    ds_read_b128 v[24:27], v2 offset:3072
    v_exp_f32 v88, v88
    v_exp_f32 v89, v89
    v_exp_f32 v90, v90
    v_exp_f32 v91, v91
    v_cvt_pk_bf16_f32 v30, v84, v85
    v_cvt_pk_bf16_f32 v31, v86, v87
    v_exp_f32 v92, v92
    v_exp_f32 v93, v93
    s_waitcnt lgkmcnt(3)
    v_mfma_f32_32x32x16_bf16 v[48:63], v[20:23], v[28:31], v[48:63]
    ds_read_b128 v[20:23], v2 offset:6144
    v_exp_f32 v94, v94
    v_exp_f32 v95, v95
    v_cvt_pk_bf16_f32 v32, v88, v89
    v_cvt_pk_bf16_f32 v33, v90, v91
    v_cvt_pk_bf16_f32 v34, v92, v93
    v_cvt_pk_bf16_f32 v35, v94, v95
    s_setprio 0
    s_waitcnt lgkmcnt(1)
    v_mfma_f32_32x32x16_bf16 v[80:95], v[12:15], v[4:7], v[64:79]
    v_exp_f32 v96, v96
    v_exp_f32 v97, v97
    v_exp_f32 v98, v98
    v_exp_f32 v99, v99
    v_mfma_f32_32x32x16_bf16 v[80:95], v[16:19], v[8:11], v[80:95]
    ds_read_b128 v[12:15], v2 offset:12288
    ds_read_b128 v[16:19], v2 offset:13312
    v_exp_f32 v100, v100
    v_exp_f32 v101, v101
    v_exp_f32 v102, v102
    v_exp_f32 v103, v103
    v_cvt_pk_bf16_f32 v36, v96, v97
    v_cvt_pk_bf16_f32 v37, v98, v99
    v_mfma_f32_32x32x16_bf16 v[48:63], v[24:27], v[32:35], v[48:63]
    ds_read_b128 v[24:27], v2 offset:7168
    v_exp_f32 v104, v104
    v_exp_f32 v105, v105
    v_exp_f32 v106, v106
    v_exp_f32 v107, v107
    v_cvt_pk_bf16_f32 v38, v100, v101
    v_cvt_pk_bf16_f32 v39, v102, v103
    v_exp_f32 v108, v108
    v_exp_f32 v109, v109
    s_waitcnt lgkmcnt(3)
    v_mfma_f32_32x32x16_bf16 v[48:63], v[20:23], v[36:39], v[48:63]
    ds_read_b128 v[20:23], v2 offset:10240
    v_exp_f32 v110, v110
    v_exp_f32 v111, v111
    v_cvt_pk_bf16_f32 v40, v104, v105
    v_cvt_pk_bf16_f32 v41, v106, v107
    v_cvt_pk_bf16_f32 v42, v108, v109
    v_cvt_pk_bf16_f32 v43, v110, v111
    s_waitcnt vmcnt(0)
    s_barrier
    s_cmp_eq_u32 s54, s55
    s_cbranch_scc1 C_OA1
C_OA1_BACK:
    s_setprio 2
    s_waitcnt lgkmcnt(1)
    v_mfma_f32_32x32x16_bf16 v[96:111], v[12:15], v[4:7], v[64:79]
    v_exp_f32 v80, v80
    v_exp_f32 v81, v81
    v_exp_f32 v82, v82
    v_exp_f32 v83, v83
    v_mfma_f32_32x32x16_bf16 v[96:111], v[16:19], v[8:11], v[96:111]
    ds_read_b128 v[12:15], v3 offset:0
    ds_read_b128 v[16:19], v3 offset:1024
    v_exp_f32 v84, v84
    v_exp_f32 v85, v85
    v_exp_f32 v86, v86
    v_exp_f32 v87, v87
    v_cvt_pk_bf16_f32 v28, v80, v81
    v_cvt_pk_bf16_f32 v29, v82, v83
    v_mfma_f32_32x32x16_bf16 v[48:63], v[24:27], v[40:43], v[48:63]
    ds_read_b128 v[24:27], v2 offset:11264
    v_exp_f32 v88, v88
    v_exp_f32 v89, v89
    v_exp_f32 v90, v90
    v_exp_f32 v91, v91
    v_cvt_pk_bf16_f32 v30, v84, v85
    v_cvt_pk_bf16_f32 v31, v86, v87
    v_exp_f32 v92, v92
    v_exp_f32 v93, v93
    s_waitcnt lgkmcnt(3)
    v_mfma_f32_32x32x16_bf16 v[48:63], v[20:23], v[28:31], v[48:63]
    ds_read_b128 v[20:23], v2 offset:14336
    v_exp_f32 v94, v94
    v_exp_f32 v95, v95
    v_cvt_pk_bf16_f32 v32, v88, v89
    v_cvt_pk_bf16_f32 v33, v90, v91
    v_cvt_pk_bf16_f32 v34, v92, v93
    v_cvt_pk_bf16_f32 v35, v94, v95
    s_waitcnt lgkmcnt(1)
    v_mfma_f32_32x32x16_bf16 v[80:95], v[12:15], v[4:7], v[64:79]
    v_exp_f32 v96, v96
    v_exp_f32 v97, v97
    v_exp_f32 v98, v98
    v_exp_f32 v99, v99
    v_mfma_f32_32x32x16_bf16 v[80:95], v[16:19], v[8:11], v[80:95]
    ds_read_b128 v[12:15], v3 offset:4096
    ds_read_b128 v[16:19], v3 offset:5120
    v_exp_f32 v100, v100
    v_exp_f32 v101, v101
    v_exp_f32 v102, v102
    v_exp_f32 v103, v103
    v_cvt_pk_bf16_f32 v36, v96, v97
    v_cvt_pk_bf16_f32 v37, v98, v99
    v_mfma_f32_32x32x16_bf16 v[48:63], v[24:27], v[32:35], v[48:63]
    ds_read_b128 v[24:27], v2 offset:15360
    v_exp_f32 v104, v104
    v_exp_f32 v105, v105
    v_exp_f32 v106, v106
    v_exp_f32 v107, v107
    v_cvt_pk_bf16_f32 v38, v100, v101
    v_cvt_pk_bf16_f32 v39, v102, v103
    v_exp_f32 v108, v108
    v_exp_f32 v109, v109
    s_waitcnt lgkmcnt(3)
    v_mfma_f32_32x32x16_bf16 v[48:63], v[20:23], v[36:39], v[48:63]
    ds_read_b128 v[20:23], v3 offset:2048
    v_exp_f32 v110, v110
    v_exp_f32 v111, v111
    v_cvt_pk_bf16_f32 v40, v104, v105
    v_cvt_pk_bf16_f32 v41, v106, v107
    v_cvt_pk_bf16_f32 v42, v108, v109
    v_cvt_pk_bf16_f32 v43, v110, v111
    v_mov_b32 v2, v3
    v_add_u32 v3, 32768, v3
    v_and_b32 v3, 0x1ffff, v3
    s_add_u32 s54, s54, 1
    s_cmp_lt_u32 s54, 8
    s_cbranch_scc1 C_LOOP
    s_waitcnt lgkmcnt(0)
    v_mfma_f32_32x32x16_bf16 v[48:63], v[24:27], v[40:43], v[48:63]
    s_setprio 0
    s_barrier
    s_nop 2
    s_nop 13
    s_cmp_eq_u32 s49, 1
    s_cbranch_scc1 C_G1
    ds_write_b128 v152, v[56:59]
    ds_write_b128 v152, v[60:63] offset:1024
    s_waitcnt lgkmcnt(0)
    s_barrier
    ds_read_b128 v[80:83], v152 offset:2048
    ds_read_b128 v[84:87], v152 offset:3072
    ds_read_b32 v44, v153
    s_waitcnt lgkmcnt(0)
    v_add_f32 v44, v44, v60
    v_add_f32 v80, v80, v48
    v_add_f32 v81, v81, v49
    v_add_f32 v82, v82, v50
    v_add_f32 v83, v83, v51
    v_add_f32 v84, v84, v52
    v_add_f32 v85, v85, v53
    v_add_f32 v86, v86, v54
    v_add_f32 v87, v87, v55
    s_branch C_FIN
C_G1:
    ds_write_b128 v152, v[48:51] offset:2048
    ds_write_b128 v152, v[52:55] offset:3072
    ds_write_b32 v153, v60
    s_waitcnt lgkmcnt(0)
    s_barrier
    ds_read_b128 v[80:83], v152
    ds_read_b128 v[84:87], v152 offset:1024
    s_waitcnt lgkmcnt(0)
    v_add_f32 v80, v80, v56
    v_add_f32 v81, v81, v57
    v_add_f32 v82, v82, v58
    v_add_f32 v83, v83, v59
    v_add_f32 v84, v84, v60
    v_add_f32 v85, v85, v61
    v_add_f32 v86, v86, v62
    v_add_f32 v87, v87, v63
    v_mov_b32 v44, v84
C_FIN:
    v_mov_b32 v45, v44
    s_nop 1
    v_permlane32_swap_b32 v44, v45
    s_nop 1
    v_mul_f32 v44, 0, v45
    v_fma_f32 v44, v80, 0, v44
    v_fma_f32 v44, v81, 0, v44
    v_fma_f32 v44, v82, 0, v44
    v_fma_f32 v44, v83, 0, v44
    v_fma_f32 v44, v84, 0, v44
    v_fma_f32 v44, v85, 0, v44
    v_fma_f32 v44, v86, 0, v44
    v_fma_f32 v44, v87, 0, v44
    v_cmp_u_f32 vcc, v44, v44
    s_nop 4
    s_cbranch_vccnz C_FALLBACK
C_STORE:
    v_rcp_f32 v45, v45
    s_nop 0
    v_mul_f32 v80, v80, v45
    v_mul_f32 v81, v81, v45
    v_mul_f32 v82, v82, v45
    v_mul_f32 v83, v83, v45
    v_mul_f32 v84, v84, v45
    v_mul_f32 v85, v85, v45
    v_mul_f32 v86, v86, v45
    v_mul_f32 v87, v87, v45
    v_cvt_pk_bf16_f32 v4, v80, v81
    v_cvt_pk_bf16_f32 v5, v82, v83
    v_cvt_pk_bf16_f32 v6, v84, v85
    v_cvt_pk_bf16_f32 v7, v86, v87
    s_cmp_eq_u32 s49, 0
    s_cbranch_scc1 C_NOPAD
    s_mov_b32 exec_lo, 0
    v_mov_b32 v6, 0
    v_mov_b32 v7, 0
    s_mov_b32 exec_lo, -1
C_NOPAD:
    buffer_store_dwordx4 v[4:7], v1, s[24:27], s57 offen sc1
    s_barrier
    s_cmp_ge_u32 s2, 224
    s_cbranch_scc1 C_DONE
    v_lshlrev_b32 v161, 10, v0
    v_add_u32 v161, 1020, v161
    s_mov_b32 s55, 64
    s_cmp_eq_u32 s49, 1
    s_cbranch_scc1 C_PB
    buffer_load_dwordx4 v[16:19], v1, s[24:27], s61 offen offset:0 sc1
    buffer_load_dwordx4 v[20:23], v1, s[24:27], s61 offen offset:1024 sc1
    buffer_load_dwordx4 v[24:27], v1, s[24:27], s61 offen offset:2048 sc1
    buffer_load_dwordx4 v[28:31], v1, s[24:27], s61 offen offset:3072 sc1
    buffer_load_dwordx4 v[32:35], v1, s[24:27], s63 offen offset:0 sc1
    buffer_load_dwordx4 v[36:39], v1, s[24:27], s63 offen offset:1024 sc1
    buffer_load_dwordx4 v[40:43], v1, s[24:27], s63 offen offset:2048 sc1
    buffer_load_dwordx4 v[44:47], v1, s[24:27], s63 offen offset:3072 sc1
    ds_read_b64_tr_b16 v[48:49], v156 offset:0
    ds_read_b64_tr_b16 v[50:51], v156 offset:1024
    ds_read_b64_tr_b16 v[52:53], v157 offset:0
    ds_read_b64_tr_b16 v[54:55], v157 offset:1024
    ds_read_b64_tr_b16 v[56:57], v156 offset:2048
    ds_read_b64_tr_b16 v[58:59], v156 offset:3072
    ds_read_b64_tr_b16 v[60:61], v157 offset:2048
    ds_read_b64_tr_b16 v[62:63], v157 offset:3072
    ds_read_b64_tr_b16 v[64:65], v156 offset:3584
    ds_read_b64_tr_b16 v[66:67], v156 offset:4608
    ds_read_b64_tr_b16 v[68:69], v157 offset:3584
    ds_read_b64_tr_b16 v[70:71], v157 offset:4608
    ds_read_b64_tr_b16 v[72:73], v156 offset:5632
    ds_read_b64_tr_b16 v[74:75], v156 offset:6656
    ds_read_b64_tr_b16 v[76:77], v157 offset:5632
    ds_read_b64_tr_b16 v[78:79], v157 offset:6656
    s_branch C_PJ
C_PB:
    ds_read_b64_tr_b16 v[48:49], v156 offset:0
    ds_read_b64_tr_b16 v[50:51], v156 offset:1024
    ds_read_b64_tr_b16 v[52:53], v157 offset:0
    ds_read_b64_tr_b16 v[54:55], v157 offset:1024
    ds_read_b64_tr_b16 v[56:57], v156 offset:2048
    ds_read_b64_tr_b16 v[58:59], v156 offset:3072
    ds_read_b64_tr_b16 v[60:61], v157 offset:2048
    ds_read_b64_tr_b16 v[62:63], v157 offset:3072
    ds_read_b64_tr_b16 v[64:65], v156 offset:3584
    ds_read_b64_tr_b16 v[66:67], v156 offset:4608
    ds_read_b64_tr_b16 v[68:69], v157 offset:3584
    ds_read_b64_tr_b16 v[70:71], v157 offset:4608
    ds_read_b64_tr_b16 v[72:73], v156 offset:5632
    ds_read_b64_tr_b16 v[74:75], v156 offset:6656
    ds_read_b64_tr_b16 v[76:77], v157 offset:5632
    ds_read_b64_tr_b16 v[78:79], v157 offset:6656
    s_mov_b64 exec, 0xffff
    s_mov_b32 s62, 262144
C_DP:
    buffer_load_dword v144, v161, s[24:27], s58 offen sc1
    s_waitcnt vmcnt(0)
    v_cmp_eq_u32 vcc, -1, v144
    s_sub_u32 s62, s62, 1
    s_nop 3
    s_cbranch_vccz C_DP_OK
    s_sleep 1
    s_cmp_lg_u32 s62, 0
    s_cbranch_scc1 C_DP
C_DP_OK:
    s_mov_b64 exec, -1
    buffer_load_dwordx4 v[112:115], v1, s[24:27], s58 offen offset:0 sc1
    buffer_load_dwordx4 v[116:119], v1, s[24:27], s58 offen offset:1024 sc1
    buffer_load_dwordx4 v[120:123], v1, s[24:27], s58 offen offset:2048 sc1
    buffer_load_dwordx4 v[124:127], v1, s[24:27], s58 offen offset:3072 sc1
    buffer_load_dwordx4 v[128:131], v1, s[24:27], s59 offen offset:0 sc1
    buffer_load_dwordx4 v[132:135], v1, s[24:27], s59 offen offset:1024 sc1
    buffer_load_dwordx4 v[136:139], v1, s[24:27], s59 offen offset:2048 sc1
    buffer_load_dwordx4 v[140:143], v1, s[24:27], s59 offen offset:3072 sc1
    buffer_load_dwordx4 v[16:19], v1, s[24:27], s61 offen offset:0 sc1
    buffer_load_dwordx4 v[20:23], v1, s[24:27], s61 offen offset:1024 sc1
    buffer_load_dwordx4 v[24:27], v1, s[24:27], s61 offen offset:2048 sc1
    buffer_load_dwordx4 v[28:31], v1, s[24:27], s61 offen offset:3072 sc1
    buffer_load_dwordx4 v[32:35], v1, s[24:27], s63 offen offset:0 sc1
    buffer_load_dwordx4 v[36:39], v1, s[24:27], s63 offen offset:1024 sc1
    buffer_load_dwordx4 v[40:43], v1, s[24:27], s63 offen offset:2048 sc1
    buffer_load_dwordx4 v[44:47], v1, s[24:27], s63 offen offset:3072 sc1
C_PJ:
    v_mov_b32 v146, 0
    s_waitcnt vmcnt(15) lgkmcnt(12)
    v_mfma_f32_32x32x16_bf16 v[80:95], v[48:51], v[112:115], 0
    v_mfma_f32_32x32x16_bf16 v[96:111], v[52:55], v[112:115], 0
    ds_read_b64_tr_b16 v[48:49], v156 offset:7168
    ds_read_b64_tr_b16 v[50:51], v156 offset:8192
    ds_read_b64_tr_b16 v[52:53], v157 offset:7168
    ds_read_b64_tr_b16 v[54:55], v157 offset:8192
    v_max3_u32 v146, v146, v112, v113
    v_max3_u32 v146, v146, v114, v115
    s_waitcnt vmcnt(14) lgkmcnt(12)
    v_mfma_f32_32x32x16_bf16 v[80:95], v[56:59], v[116:119], v[80:95]
    v_mfma_f32_32x32x16_bf16 v[96:111], v[60:63], v[116:119], v[96:111]
    ds_read_b64_tr_b16 v[56:57], v156 offset:9216
    ds_read_b64_tr_b16 v[58:59], v156 offset:10240
    ds_read_b64_tr_b16 v[60:61], v157 offset:9216
    ds_read_b64_tr_b16 v[62:63], v157 offset:10240
    v_max3_u32 v146, v146, v116, v117
    v_max3_u32 v146, v146, v118, v119
    s_waitcnt vmcnt(13) lgkmcnt(12)
    v_mfma_f32_32x32x16_bf16 v[80:95], v[64:67], v[120:123], v[80:95]
    v_mfma_f32_32x32x16_bf16 v[96:111], v[68:71], v[120:123], v[96:111]
    ds_read_b64_tr_b16 v[64:65], v156 offset:10752
    ds_read_b64_tr_b16 v[66:67], v156 offset:11776
    ds_read_b64_tr_b16 v[68:69], v157 offset:10752
    ds_read_b64_tr_b16 v[70:71], v157 offset:11776
    v_max3_u32 v146, v146, v120, v121
    v_max3_u32 v146, v146, v122, v123
    s_waitcnt vmcnt(12) lgkmcnt(12)
    v_mfma_f32_32x32x16_bf16 v[80:95], v[72:75], v[124:127], v[80:95]
    v_mfma_f32_32x32x16_bf16 v[96:111], v[76:79], v[124:127], v[96:111]
    ds_read_b64_tr_b16 v[72:73], v156 offset:12800
    ds_read_b64_tr_b16 v[74:75], v156 offset:13824
    ds_read_b64_tr_b16 v[76:77], v157 offset:12800
    ds_read_b64_tr_b16 v[78:79], v157 offset:13824
    v_max3_u32 v146, v146, v124, v125
    v_max3_u32 v146, v146, v126, v127
    s_waitcnt vmcnt(11) lgkmcnt(12)
    v_mfma_f32_32x32x16_bf16 v[80:95], v[48:51], v[128:131], v[80:95]
    v_mfma_f32_32x32x16_bf16 v[96:111], v[52:55], v[128:131], v[96:111]
    ds_read_b64_tr_b16 v[48:49], v156 offset:14336
    ds_read_b64_tr_b16 v[50:51], v156 offset:15360
    ds_read_b64_tr_b16 v[52:53], v157 offset:14336
    ds_read_b64_tr_b16 v[54:55], v157 offset:15360
    v_max3_u32 v146, v146, v128, v129
    v_max3_u32 v146, v146, v130, v131
    s_waitcnt vmcnt(10) lgkmcnt(12)
    v_mfma_f32_32x32x16_bf16 v[80:95], v[56:59], v[132:135], v[80:95]
    v_mfma_f32_32x32x16_bf16 v[96:111], v[60:63], v[132:135], v[96:111]
    ds_read_b64_tr_b16 v[56:57], v156 offset:16384
    ds_read_b64_tr_b16 v[58:59], v156 offset:17408
    ds_read_b64_tr_b16 v[60:61], v157 offset:16384
    ds_read_b64_tr_b16 v[62:63], v157 offset:17408
    v_max3_u32 v146, v146, v132, v133
    v_max3_u32 v146, v146, v134, v135
    s_waitcnt vmcnt(9) lgkmcnt(12)
    v_mfma_f32_32x32x16_bf16 v[80:95], v[64:67], v[136:139], v[80:95]
    v_mfma_f32_32x32x16_bf16 v[96:111], v[68:71], v[136:139], v[96:111]
    ds_read_b64_tr_b16 v[64:65], v156 offset:17920
    ds_read_b64_tr_b16 v[66:67], v156 offset:18944
    ds_read_b64_tr_b16 v[68:69], v157 offset:17920
    ds_read_b64_tr_b16 v[70:71], v157 offset:18944
    v_max3_u32 v146, v146, v136, v137
    v_max3_u32 v146, v146, v138, v139
    s_waitcnt vmcnt(8) lgkmcnt(12)
    v_mfma_f32_32x32x16_bf16 v[80:95], v[72:75], v[140:143], v[80:95]
    v_mfma_f32_32x32x16_bf16 v[96:111], v[76:79], v[140:143], v[96:111]
    ds_read_b64_tr_b16 v[72:73], v156 offset:19968
    ds_read_b64_tr_b16 v[74:75], v156 offset:20992
    ds_read_b64_tr_b16 v[76:77], v157 offset:19968
    ds_read_b64_tr_b16 v[78:79], v157 offset:20992
    v_max3_u32 v146, v146, v140, v141
    v_max3_u32 v146, v146, v142, v143
    s_waitcnt vmcnt(7) lgkmcnt(12)
    v_mfma_f32_32x32x16_bf16 v[80:95], v[48:51], v[16:19], v[80:95]
    v_mfma_f32_32x32x16_bf16 v[96:111], v[52:55], v[16:19], v[96:111]
    ds_read_b64_tr_b16 v[48:49], v156 offset:21504
    ds_read_b64_tr_b16 v[50:51], v156 offset:22528
    ds_read_b64_tr_b16 v[52:53], v157 offset:21504
    ds_read_b64_tr_b16 v[54:55], v157 offset:22528
    v_max3_u32 v146, v146, v16, v17
    v_max3_u32 v146, v146, v18, v19
    s_waitcnt vmcnt(6) lgkmcnt(12)
    v_mfma_f32_32x32x16_bf16 v[80:95], v[56:59], v[20:23], v[80:95]
    v_mfma_f32_32x32x16_bf16 v[96:111], v[60:63], v[20:23], v[96:111]
    ds_read_b64_tr_b16 v[56:57], v156 offset:23552
    ds_read_b64_tr_b16 v[58:59], v156 offset:24576
    ds_read_b64_tr_b16 v[60:61], v157 offset:23552
    ds_read_b64_tr_b16 v[62:63], v157 offset:24576
    v_max3_u32 v146, v146, v20, v21
    v_max3_u32 v146, v146, v22, v23
    s_waitcnt vmcnt(5) lgkmcnt(12)
    v_mfma_f32_32x32x16_bf16 v[80:95], v[64:67], v[24:27], v[80:95]
    v_mfma_f32_32x32x16_bf16 v[96:111], v[68:71], v[24:27], v[96:111]
    ds_read_b64_tr_b16 v[64:65], v156 offset:25088
    ds_read_b64_tr_b16 v[66:67], v156 offset:26112
    ds_read_b64_tr_b16 v[68:69], v157 offset:25088
    ds_read_b64_tr_b16 v[70:71], v157 offset:26112
    v_max3_u32 v146, v146, v24, v25
    v_max3_u32 v146, v146, v26, v27
    s_waitcnt vmcnt(4) lgkmcnt(12)
    v_mfma_f32_32x32x16_bf16 v[80:95], v[72:75], v[28:31], v[80:95]
    v_mfma_f32_32x32x16_bf16 v[96:111], v[76:79], v[28:31], v[96:111]
    ds_read_b64_tr_b16 v[72:73], v156 offset:27136
    ds_read_b64_tr_b16 v[74:75], v156 offset:28160
    ds_read_b64_tr_b16 v[76:77], v157 offset:27136
    ds_read_b64_tr_b16 v[78:79], v157 offset:28160
    v_max3_u32 v146, v146, v28, v29
    v_max3_u32 v146, v146, v30, v31
    s_waitcnt vmcnt(3) lgkmcnt(12)
    v_mfma_f32_32x32x16_bf16 v[80:95], v[48:51], v[32:35], v[80:95]
    v_mfma_f32_32x32x16_bf16 v[96:111], v[52:55], v[32:35], v[96:111]
    v_max3_u32 v146, v146, v32, v33
    v_max3_u32 v146, v146, v34, v35
    s_waitcnt vmcnt(2) lgkmcnt(8)
    v_mfma_f32_32x32x16_bf16 v[80:95], v[56:59], v[36:39], v[80:95]
    v_mfma_f32_32x32x16_bf16 v[96:111], v[60:63], v[36:39], v[96:111]
    v_max3_u32 v146, v146, v36, v37
    v_max3_u32 v146, v146, v38, v39
    s_waitcnt vmcnt(1) lgkmcnt(4)
    v_mfma_f32_32x32x16_bf16 v[80:95], v[64:67], v[40:43], v[80:95]
    v_mfma_f32_32x32x16_bf16 v[96:111], v[68:71], v[40:43], v[96:111]
    v_max3_u32 v146, v146, v40, v41
    v_max3_u32 v146, v146, v42, v43
    s_waitcnt vmcnt(0) lgkmcnt(0)
    v_mfma_f32_32x32x16_bf16 v[80:95], v[72:75], v[44:47], v[80:95]
    v_mfma_f32_32x32x16_bf16 v[96:111], v[76:79], v[44:47], v[96:111]
    v_max3_u32 v146, v146, v44, v45
    v_max3_u32 v146, v146, v46, v47
    v_cmp_eq_u32 vcc, -1, v146
    s_sub_u32 s55, s55, 1
    s_mul_i32 s3, s55, s49
    s_nop 2
    s_cbranch_vccz C_POK
    s_cmp_lg_u32 s3, 0
    s_cbranch_scc1 C_PB
C_POK:
    s_nop 15
    s_cmp_eq_u32 s53, 0
    s_cbranch_scc1 C_KH0
    ds_write_b128 v160, v[80:83] offset:0
    ds_write_b128 v160, v[84:87] offset:1024
    ds_write_b128 v160, v[88:91] offset:2048
    ds_write_b128 v160, v[92:95] offset:3072
    v_mov_b32 v80, v96
    v_mov_b32 v81, v97
    v_mov_b32 v82, v98
    v_mov_b32 v83, v99
    v_mov_b32 v84, v100
    v_mov_b32 v85, v101
    v_mov_b32 v86, v102
    v_mov_b32 v87, v103
    v_mov_b32 v88, v104
    v_mov_b32 v89, v105
    v_mov_b32 v90, v106
    v_mov_b32 v91, v107
    v_mov_b32 v92, v108
    v_mov_b32 v93, v109
    v_mov_b32 v94, v110
    v_mov_b32 v95, v111
    s_branch C_KHJ
C_KH0:
    ds_write_b128 v160, v[96:99] offset:0
    ds_write_b128 v160, v[100:103] offset:1024
    ds_write_b128 v160, v[104:107] offset:2048
    ds_write_b128 v160, v[108:111] offset:3072
C_KHJ:
    s_waitcnt lgkmcnt(0)
    s_barrier
    ds_read_b128 v[96:99], v159 offset:0
    ds_read_b128 v[100:103], v159 offset:1024
    ds_read_b128 v[104:107], v159 offset:2048
    ds_read_b128 v[108:111], v159 offset:3072
    s_waitcnt lgkmcnt(3)
    v_add_f32 v80, v80, v96
    v_add_f32 v81, v81, v97
    v_add_f32 v82, v82, v98
    v_add_f32 v83, v83, v99
    s_waitcnt lgkmcnt(2)
    v_add_f32 v84, v84, v100
    v_add_f32 v85, v85, v101
    v_add_f32 v86, v86, v102
    v_add_f32 v87, v87, v103
    s_waitcnt lgkmcnt(1)
    v_add_f32 v88, v88, v104
    v_add_f32 v89, v89, v105
    v_add_f32 v90, v90, v106
    v_add_f32 v91, v91, v107
    s_waitcnt lgkmcnt(0)
    v_add_f32 v92, v92, v108
    v_add_f32 v93, v93, v109
    v_add_f32 v94, v94, v110
    v_add_f32 v95, v95, v111
    v_cvt_pk_bf16_f32 v8, v80, v81
    v_cvt_pk_bf16_f32 v9, v82, v83
    v_cvt_pk_bf16_f32 v10, v84, v85
    v_cvt_pk_bf16_f32 v11, v86, v87
    v_cvt_pk_bf16_f32 v12, v88, v89
    v_cvt_pk_bf16_f32 v13, v90, v91
    v_cvt_pk_bf16_f32 v14, v92, v93
    v_cvt_pk_bf16_f32 v15, v94, v95
    s_nop 1
    v_permlane32_swap_b32 v8, v10
    v_permlane32_swap_b32 v9, v11
    v_permlane32_swap_b32 v12, v14
    v_permlane32_swap_b32 v13, v15
    s_nop 1
    buffer_store_dwordx4 v[8:11], v158, s[36:39], s60 offen nt
    buffer_store_dwordx4 v[12:15], v158, s[36:39], s60 offen offset:32 nt
    s_or_b32 s3, s2, s40
    s_cmp_lg_u32 s3, 0
    s_cbranch_scc1 C_DONE
    s_mov_b32 s3, 0x1000000
    s_mov_b64 exec, 1
    buffer_store_dword v165, v166, s[24:27], s3 offen sc1
    s_mov_b64 exec, -1
C_DONE:
    s_endpgm
C_OA1:
    buffer_load_dwordx4 v[112:115], v1, s[24:27], s58 offen offset:0 sc1
    buffer_load_dwordx4 v[116:119], v1, s[24:27], s58 offen offset:1024 sc1
    buffer_load_dwordx4 v[120:123], v1, s[24:27], s58 offen offset:2048 sc1
    buffer_load_dwordx4 v[124:127], v1, s[24:27], s58 offen offset:3072 sc1
    buffer_load_dwordx4 v[128:131], v1, s[24:27], s59 offen offset:0 sc1
    buffer_load_dwordx4 v[132:135], v1, s[24:27], s59 offen offset:1024 sc1
    buffer_load_dwordx4 v[136:139], v1, s[24:27], s59 offen offset:2048 sc1
    buffer_load_dwordx4 v[140:143], v1, s[24:27], s59 offen offset:3072 sc1
    s_branch C_OA1_BACK
C_FALLBACK:
    s_lshl_b32 s62, s43, 18
    s_add_u32 s62, s62, 0x200000
    s_mov_b32 s3, 0xff61b1e6
    v_mov_b32 v44, s3
    s_mov_b32 s55, 0
    s_mov_b32 s3, s62
C_FB1:
    buffer_load_dwordx4 v[12:15], v1, s[24:27], s3 offen sc1
    buffer_load_dwordx4 v[16:19], v1, s[24:27], s3 offen offset:1024 sc1
    s_waitcnt vmcnt(0)
    v_mfma_f32_32x32x16_bf16 v[96:111], v[12:15], v[4:7], 0
    v_mfma_f32_32x32x16_bf16 v[96:111], v[16:19], v[8:11], v[96:111]
    s_nop 15
    s_nop 3
    v_max3_f32 v45, v96, v97, v98
    v_max3_f32 v45, v45, v99, v100
    v_max3_f32 v45, v45, v101, v102
    v_max3_f32 v45, v45, v103, v104
    v_max3_f32 v45, v45, v105, v106
    v_max3_f32 v45, v45, v107, v108
    v_max3_f32 v45, v45, v109, v110
    v_max3_f32 v45, v45, v111, v44
    v_mov_b32 v44, v45
    s_add_u32 s3, s3, 4096
    s_add_u32 s55, s55, 1
    s_cmp_lt_u32 s55, 64
    s_cbranch_scc1 C_FB1
    v_mov_b32 v45, v44
    s_nop 1
    v_permlane32_swap_b32 v44, v45
    s_nop 1
    v_max_f32 v44, v44, v45
    v_sub_f32 v64, 0, v44
    v_sub_f32 v65, 0, v44
    v_sub_f32 v66, 0, v44
    v_sub_f32 v67, 0, v44
    v_sub_f32 v68, 0, v44
    v_sub_f32 v69, 0, v44
    v_sub_f32 v70, 0, v44
    v_sub_f32 v71, 0, v44
    v_sub_f32 v72, 0, v44
    v_sub_f32 v73, 0, v44
    v_sub_f32 v74, 0, v44
    v_sub_f32 v75, 0, v44
    v_sub_f32 v76, 0, v44
    v_sub_f32 v77, 0, v44
    v_sub_f32 v78, 0, v44
    v_sub_f32 v79, 0, v44
    v_mov_b32 v48, 0
    v_mov_b32 v49, 0
    v_mov_b32 v50, 0
    v_mov_b32 v51, 0
    v_mov_b32 v52, 0
    v_mov_b32 v53, 0
    v_mov_b32 v54, 0
    v_mov_b32 v55, 0
    v_mov_b32 v56, 0
    v_mov_b32 v57, 0
    v_mov_b32 v58, 0
    v_mov_b32 v59, 0
    v_mov_b32 v60, 0
    v_mov_b32 v61, 0
    v_mov_b32 v62, 0
    v_mov_b32 v63, 0
    s_mov_b32 s55, 0
    s_mov_b32 s3, s62
C_FB2:
    buffer_load_dwordx4 v[12:15], v1, s[24:27], s3 offen sc1
    buffer_load_dwordx4 v[16:19], v1, s[24:27], s3 offen offset:1024 sc1
    buffer_load_dwordx4 v[20:23], v1, s[24:27], s3 offen offset:2048 sc1
    buffer_load_dwordx4 v[24:27], v1, s[24:27], s3 offen offset:3072 sc1
    s_waitcnt vmcnt(0)
    v_mfma_f32_32x32x16_bf16 v[96:111], v[12:15], v[4:7], v[64:79]
    v_mfma_f32_32x32x16_bf16 v[96:111], v[16:19], v[8:11], v[96:111]
    s_nop 15
    s_nop 3
    v_exp_f32 v96, v96
    v_exp_f32 v97, v97
    v_exp_f32 v98, v98
    v_exp_f32 v99, v99
    v_exp_f32 v100, v100
    v_exp_f32 v101, v101
    v_exp_f32 v102, v102
    v_exp_f32 v103, v103
    v_exp_f32 v104, v104
    v_exp_f32 v105, v105
    v_exp_f32 v106, v106
    v_exp_f32 v107, v107
    v_exp_f32 v108, v108
    v_exp_f32 v109, v109
    v_exp_f32 v110, v110
    v_exp_f32 v111, v111
    s_nop 0
    v_cvt_pk_bf16_f32 v28, v96, v97
    v_cvt_pk_bf16_f32 v29, v98, v99
    v_cvt_pk_bf16_f32 v30, v100, v101
    v_cvt_pk_bf16_f32 v31, v102, v103
    v_cvt_pk_bf16_f32 v32, v104, v105
    v_cvt_pk_bf16_f32 v33, v106, v107
    v_cvt_pk_bf16_f32 v34, v108, v109
    v_cvt_pk_bf16_f32 v35, v110, v111
    s_nop 1
    v_mfma_f32_32x32x16_bf16 v[48:63], v[20:23], v[28:31], v[48:63]
    v_mfma_f32_32x32x16_bf16 v[48:63], v[24:27], v[32:35], v[48:63]
    s_add_u32 s3, s3, 4096
    s_add_u32 s55, s55, 1
    s_cmp_lt_u32 s55, 64
    s_cbranch_scc1 C_FB2
    s_nop 15
    s_nop 3
    v_mov_b32 v44, v60
    v_mov_b32 v45, v60
    s_nop 1
    v_permlane32_swap_b32 v44, v45
    s_cmp_eq_u32 s49, 0
    s_cbranch_scc1 C_FB3
    v_mov_b32 v48, v56
    v_mov_b32 v49, v57
    v_mov_b32 v50, v58
    v_mov_b32 v51, v59
    v_mov_b32 v52, v60
    v_mov_b32 v53, v61
    v_mov_b32 v54, v62
    v_mov_b32 v55, v63
C_FB3:
    v_mov_b32 v80, v48
    v_mov_b32 v81, v49
    v_mov_b32 v82, v50
    v_mov_b32 v83, v51
    v_mov_b32 v84, v52
    v_mov_b32 v85, v53
    v_mov_b32 v86, v54
    v_mov_b32 v87, v55
    s_branch C_STORE
L_END:
    s_endpgm
.section .rodata,"a"
.p2align 6
.amdhsa_kernel concat_heads__sliding_local_dilated__softmax_full_mha__prompt_kernel
  .amdhsa_next_free_vgpr 168
  .amdhsa_next_free_sgpr 100
  .amdhsa_accum_offset 168
  .amdhsa_group_segment_fixed_size 0
  .amdhsa_kernarg_size 72
  .amdhsa_user_sgpr_count 2
  .amdhsa_user_sgpr_kernarg_segment_ptr 1
  .amdhsa_system_sgpr_workgroup_id_x 1
.end_amdhsa_kernel
```
